```python
import torch

def _softmax(x, axis=-1):
    return torch.softmax(x, dim=axis)
def _gelu(x):
    return torch.nn.functional.gelu(x, approximate="tanh")
def _silu(x):
    return torch.nn.functional.silu(x)
def _sigmoid(x):
    return torch.sigmoid(x)
def _layernorm(x, axis=-1, eps=1e-5):
    m = x.mean(dim=axis, keepdim=True)
    v = x.var(dim=axis, keepdim=True, unbiased=False)
    return (x - m) / torch.sqrt(v + eps)
def _scatter_add(tgt, idx, src, axis=0):
    return tgt.clone().index_add_(axis, idx, src)
def _segment_sum(src, seg, n):
    out = torch.zeros((n,) + src.shape[1:], dtype=src.dtype)
    return out.index_add_(0, seg, src)
def _pad(x, pw):
    flat = tuple(v for pair in reversed(pw) for v in pair)
    return torch.nn.functional.pad(x, flat)

kernel_name = 'interleave_layers__sliding_local_dilated__sliding_local_dilated__prompt'

def setup_inputs():

    _w = (lambda a: (lambda t: t.to(torch.bfloat16) if t.is_floating_point() else t)(torch.as_tensor(a)))
    def _A_setup():
        B, S, D = 1, 2048, 1024
        return {
            "x": _w((lambda *s: torch.randn(*s, dtype=torch.bfloat16) * 0.05)(B, S, D)),
            "wqkv": _w((lambda *s: torch.randn(*s, dtype=torch.bfloat16) * 0.05)(D, 3 * D)),
            "wo": _w((lambda *s: torch.randn(*s, dtype=torch.bfloat16) * 0.05)(D, D)),
        }
    _A_in = _A_setup()

    def _B_setup():
        B, S, D = 1, 2048, 1024
        return {
            "x": _w((lambda *s: torch.randn(*s, dtype=torch.bfloat16) * 0.05)(B, S, D)),
            "wqkv": _w((lambda *s: torch.randn(*s, dtype=torch.bfloat16) * 0.05)(D, 3 * D)),
            "wo": _w((lambda *s: torch.randn(*s, dtype=torch.bfloat16) * 0.05)(D, D)),
        }
    _B_in = _B_setup()

    return {
        "A_x": _A_in["x"],
        "A_wqkv": _A_in["wqkv"],
        "A_wo": _A_in["wo"],
        "B_x": _B_in["x"],
        "B_wqkv": _B_in["wqkv"],
        "B_wo": _B_in["wo"],
    }

def reference(A_x, A_wqkv, A_wo, B_x, B_wqkv, B_wo):
    def _A_ref(x, wqkv, wo):
        B, S, D = x.shape
        H = 32; Dh = D // H
        W, dil = 8, 2
        qkv = (lambda x, *d: x.permute(*d))((x @ wqkv).reshape(B, S, 3, H, Dh), 2, 0, 3, 1, 4)
        q, k, v = qkv[0], qkv[1], qkv[2]
        scale = Dh ** -0.5
        pos = torch.arange(S)
        off = torch.arange(W) * dil
        idx = pos[:, None] - off[None, :]
        mask = idx >= 0
        idx_c = torch.where(mask, idx, 0).reshape(-1)
        kg = k[:, :, idx_c, :].reshape(B, H, S, W, Dh)
        vg = v[:, :, idx_c, :].reshape(B, H, S, W, Dh)
        logits = torch.einsum("bhsd,bhswd->bhsw", q, kg) * scale
        logits = torch.where(mask[None, None, :, :], logits, -1e9)
        attn = _softmax(logits, axis=-1)
        o = torch.einsum("bhsw,bhswd->bhsd", attn, vg)
        return (lambda x, *d: x.permute(*d))(o, 0, 2, 1, 3).reshape(B, S, D) @ wo

    def _B_ref(x, wqkv, wo):
        B, S, D = x.shape
        H = 32; Dh = D // H
        W, dil = 8, 2
        qkv = (lambda x, *d: x.permute(*d))((x @ wqkv).reshape(B, S, 3, H, Dh), 2, 0, 3, 1, 4)
        q, k, v = qkv[0], qkv[1], qkv[2]
        scale = Dh ** -0.5
        pos = torch.arange(S)
        off = torch.arange(W) * dil
        idx = pos[:, None] - off[None, :]
        mask = idx >= 0
        idx_c = torch.where(mask, idx, 0).reshape(-1)
        kg = k[:, :, idx_c, :].reshape(B, H, S, W, Dh)
        vg = v[:, :, idx_c, :].reshape(B, H, S, W, Dh)
        logits = torch.einsum("bhsd,bhswd->bhsw", q, kg) * scale
        logits = torch.where(mask[None, None, :, :], logits, -1e9)
        attn = _softmax(logits, axis=-1)
        o = torch.einsum("bhsw,bhswd->bhsd", attn, vg)
        return (lambda x, *d: x.permute(*d))(o, 0, 2, 1, 3).reshape(B, S, D) @ wo

    x = A_x
    x = x + _A_ref(_layernorm(x, axis=-1), A_wqkv, A_wo)
    x = x + _B_ref(_layernorm(x, axis=-1), B_wqkv, B_wo)
    x = x + _A_ref(_layernorm(x, axis=-1), A_wqkv, A_wo)
    x = x + _B_ref(_layernorm(x, axis=-1), B_wqkv, B_wo)
    return x
```

```asm
; @launch grid=(256,1,1) block=(512,1,1) lds=156672
.amdgcn_target "amdgcn-amd-amdhsa--gfx950"
.text
.globl interleave_layers__sliding_local_dilated__sliding_local_dilated__prompt_kernel
.p2align 8
.type interleave_layers__sliding_local_dilated__sliding_local_dilated__prompt_kernel,@function
interleave_layers__sliding_local_dilated__sliding_local_dilated__prompt_kernel:
  s_cmp_ge_u32 s2, 256
  s_cbranch_scc1 m_exit
  s_load_dwordx2 s[38:39], s[0:1], 0
  s_load_dwordx2 s[42:43], s[0:1], 8
  s_load_dwordx2 s[46:47], s[0:1], 16
  s_load_dwordx2 s[44:45], s[0:1], 32
  s_load_dwordx2 s[48:49], s[0:1], 40
  s_load_dwordx2 s[40:41], s[0:1], 48
  s_load_dwordx2 s[80:81], s[0:1], 56
  s_load_dwordx2 s[36:37], s[0:1], 64
  s_and_b32 s57, s2, 7
  s_lshr_b32 s58, s2, 3
  s_and_b32 s51, s57, 1
  s_lshl_b32 s51, s51, 3
  s_and_b32 s59, s58, 7
  s_add_u32 s51, s51, s59
  s_lshr_b32 s52, s57, 1
  s_lshl_b32 s52, s52, 2
  s_lshr_b32 s59, s58, 3
  s_add_u32 s52, s52, s59
  s_and_b32 s59, s57, 1
  s_lshl_b32 s59, s59, 1
  s_bfe_u32 s60, s57, 0x10001
  s_or_b32 s59, s59, s60
  s_and_b32 s57, s57, 4
  s_or_b32 s57, s57, s59
  s_and_b32 s53, s57, 3
  s_lshl_b32 s53, s53, 2
  s_and_b32 s59, s58, 3
  s_add_u32 s53, s53, s59
  s_lshr_b32 s54, s57, 2
  s_lshl_b32 s54, s54, 3
  s_lshr_b32 s59, s58, 2
  s_add_u32 s54, s54, s59
  s_lshr_b32 s59, s2, 2
  s_and_b32 s59, s59, 1
  s_lshr_b32 s60, s58, 2
  s_mul_i32 s61, s59, 6
  s_add_u32 s61, s61, s60
  s_lshl_b32 s59, s59, 1
  s_add_u32 s59, s59, s60
  s_add_u32 s59, s59, 6
  s_cmp_ge_u32 s60, 6
  s_cselect_b32 s54, s59, s61
  v_lshrrev_b32 v1, 6, v0
  s_nop 0
  v_readfirstlane_b32 s55, v1
  v_and_b32_e64 v247, 63, v0
  s_waitcnt lgkmcnt(0)
  s_mov_b32 s6, 4194304
  s_mov_b32 s7, 0x20000
  s_mov_b32 s10, 6291456
  s_mov_b32 s11, 0x20000
  s_mov_b32 s14, 4194304
  s_mov_b32 s15, 0x20000
  s_mov_b32 s18, 262144
  s_mov_b32 s19, 0x20000
  s_mov_b32 s22, 2097152
  s_mov_b32 s23, 0x20000
  s_mov_b32 s26, 4194304
  s_mov_b32 s27, 0x20000
  s_mov_b32 s30, 262144
  s_mov_b32 s31, 0x20000
  s_add_u32 s32, s36, 35651584
  s_addc_u32 s33, s37, 0
  s_mov_b32 s34, 2359296
  s_mov_b32 s35, 0x20000
  s_mov_b32 s82, 256
  s_mov_b32 s83, 0x20000
  s_cmp_ge_u32 s55, 4
  s_cbranch_scc1 loader
  s_and_b32 s56, s55, 1
  s_mov_b32 s50, 0
  v_mov_b32 v1, 156288
  v_mov_b32 v2, 0
  v_mov_b32 v3, 0
  v_mov_b32 v4, 0
  v_mov_b32_e64 v5, 0
  ds_write_b128 v1, v[2:5]
  v_and_b32 v1, 15, v247
  v_lshrrev_b32 v2, 4, v247
  v_and_b32_e64 v3, 1, v1
  v_lshl_add_u32 v2, v2, 2, v3
  v_cmp_eq_u32 s[94:95], 1, v3
  v_cmp_le_u32 s[96:97], v2, v1
  v_add_u32_e64 v2, 2, v2
  v_cmp_le_u32 s[98:99], v2, v1
  v_mov_b32 v5, 1073741824
  v_cmp_le_u32_e64 vcc, 24, v247
  s_nop 1
  v_cndmask_b32 v8, 0, 1, vcc
  v_mul_u32_u24 v9, 24, v8
  v_sub_u32 v9, v247, v9
  v_lshrrev_b32 v3, 3, v9
  v_and_b32 v9, 7, v9
  v_lshl_add_u32 v9, v8, 6, v9
  s_and_b32 s65, s51, 7
  s_lshl_b32 s65, s65, 3
  s_lshl_b32 s66, s55, 7
  s_add_u32 s65, s65, s66
  v_add_u32_e64 v9, s65, v9
  s_mov_b32 s65, 6144
  v_mul_lo_u32 v9, v9, s65
  v_lshl_add_u32 v9, v3, 11, v9
  s_lshl_b32 s65, s52, 7
  v_add_u32 v252, s65, v9
  v_cmp_le_u32 vcc, 48, v247
  s_nop 1
  v_cndmask_b32 v252, v252, v5, vcc
  v_mov_b32 v143, 0
c_layer:
  s_lshl_b32 s57, s50, 22
  s_add_u32 s58, s36, s57
  s_addc_u32 s59, s37, 0
  s_cmp_eq_u32 s50, 0
  s_cselect_b32 s4, s38, s58
  s_cselect_b32 s5, s39, s59
  s_mov_b32 s57, 262144
  s_cselect_b32 s18, 16384, s57
  s_add_u32 s12, s58, 16777216
  s_addc_u32 s13, s59, 0
  s_add_u32 s58, s58, 4194304
  s_addc_u32 s59, s59, 0
  s_cmp_eq_u32 s50, 3
  s_cselect_b32 s24, s40, s58
  s_cselect_b32 s25, s41, s59
  s_lshl_b32 s57, s50, 18
  s_add_u32 s57, s57, 33554432
  s_add_u32 s16, s36, s57
  s_addc_u32 s17, s37, 0
  s_add_u32 s28, s16, 262144
  s_addc_u32 s29, s17, 0
  s_bitcmp1_b32 s50, 0
  s_cselect_b32 s8, s44, s42
  s_cselect_b32 s9, s45, s43
  s_cselect_b32 s20, s48, s46
  s_cselect_b32 s21, s49, s47
  s_mov_b32 s89, -1
  s_mov_b32 s88, 1
  s_cmp_lg_u32 s50, 0
  s_cbranch_scc1 c_norow
  s_mov_b32 s89, 2
  s_mov_b32 s88, 3
  s_cmp_lg_u32 s55, 0
  s_cbranch_scc1 c_notag
  buffer_load_dword v142, v143, s[80:83], 0 offen sc1
c_notag:
  v_lshlrev_b32_e64 v3, 4, v247
  s_lshl_b32 s57, s2, 3
  s_lshl_b32 s58, s55, 1
  s_add_u32 s57, s57, s58
  s_lshl_b32 s57, s57, 11
  buffer_load_dwordx4 v[104:107], v3, s[4:7], s57 offen
  s_add_u32 s57, s57, 1024
  buffer_load_dwordx4 v[108:111], v3, s[4:7], s57 offen
  s_add_u32 s57, s57, 1024
  buffer_load_dwordx4 v[112:115], v3, s[4:7], s57 offen
  s_add_u32 s57, s57, 1024
  buffer_load_dwordx4 v[116:119], v3, s[4:7], s57 offen
  s_or_b32 s57, s2, s55
  s_cmp_lg_u32 s57, 0
  s_cbranch_scc1 c_norow
  s_memrealtime s[60:61]
  s_waitcnt vmcnt(4) lgkmcnt(0)
  v_readfirstlane_b32 s93, v142
  s_nop 3
  s_cmp_lg_u32 s93, 0
  s_cbranch_scc1 c_norow
  s_or_b32 s57, s60, 1
  v_mov_b32_e64 v142, s57
  s_mov_b64 exec, 1
  buffer_store_dword v142, v143, s[80:83], 0 offen sc1
  s_mov_b64 exec, -1
c_norow:
  v_lshrrev_b32 v1, 3, v247
  s_mov_b32 s57, 18432
  v_mul_lo_u32 v1, v1, s57
  v_and_b32_e64 v2, 7, v247
  v_lshl_add_u32 v1, v2, 4, v1
  v_mov_b32 v4, 0x3f803f80
  v_mov_b32 v5, 0x3f803f80
  v_mov_b32 v6, 0x3f803f80
  v_mov_b32 v7, 0x3f803f80
  s_mov_b32 exec_hi, 0
  s_mov_b32 exec_lo, 0xffffff
  ds_write_b128 v1, v[4:7]
  s_mov_b64 exec, -1
  v_and_b32 v1, 15, v247
  v_lshrrev_b32 v2, 4, v247
  v_lshrrev_b32 v3, 1, v1
  v_xor_b32 v4, v2, v3
  v_lshlrev_b32_e64 v4, 4, v4
  v_lshl_add_u32 v192, v1, 7, v4
  v_xor_b32 v193, 64, v192
  v_lshrrev_b32 v3, 2, v1
  v_and_b32 v4, 3, v1
  v_lshrrev_b32 v5, 1, v3
  v_and_b32_e64 v6, 1, v2
  v_lshl_or_b32 v5, v6, 1, v5
  v_lshlrev_b32 v5, 1, v5
  v_lshrrev_b32 v6, 1, v4
  s_lshl_b32 s57, s56, 2
  v_add_u32 v6, s57, v6
  v_xor_b32 v6, v6, v5
  v_lshlrev_b32 v6, 4, v6
  v_and_b32_e64 v7, 1, v4
  v_lshl_add_u32 v6, v7, 3, v6
  v_lshl_add_u32 v7, v2, 3, v3
  v_lshl_add_u32 v6, v7, 7, v6
  v_add_u32 v194, 55296, v6
  v_xor_b32 v195, 32, v194
  v_mov_b32 v0, 0
  v_mov_b32 v1, 0
  v_mov_b32 v2, 0
  v_mov_b32 v3, 0
  v_mov_b32 v4, 0
  v_mov_b32 v5, 0
  v_mov_b32 v6, 0
  v_mov_b32 v7, 0
  v_mov_b32 v8, 0
  v_mov_b32 v9, 0
  v_mov_b32 v10, 0
  v_mov_b32 v11, 0
  v_mov_b32 v12, 0
  v_mov_b32 v13, 0
  v_mov_b32 v14, 0
  v_mov_b32 v15, 0
  v_mov_b32 v16, 0
  v_mov_b32 v17, 0
  v_mov_b32 v18, 0
  v_mov_b32 v19, 0
  v_mov_b32 v20, 0
  v_mov_b32 v21, 0
  v_mov_b32 v22, 0
  v_mov_b32 v23, 0
  v_mov_b32 v24, 0
  v_mov_b32 v25, 0
  v_mov_b32 v26, 0
  v_mov_b32 v27, 0
  v_mov_b32 v28, 0
  v_mov_b32 v29, 0
  v_mov_b32 v30, 0
  v_mov_b32 v31, 0
  v_mov_b32 v32, 0
  v_mov_b32 v33, 0
  v_mov_b32 v34, 0
  v_mov_b32 v35, 0
  v_mov_b32 v36, 0
  v_mov_b32 v37, 0
  v_mov_b32 v38, 0
  v_mov_b32 v39, 0
  v_mov_b32 v40, 0
  v_mov_b32 v41, 0
  v_mov_b32 v42, 0
  v_mov_b32 v43, 0
  v_mov_b32 v44, 0
  v_mov_b32 v45, 0
  v_mov_b32 v46, 0
  v_mov_b32 v47, 0
  v_mov_b32 v48, 0
  v_mov_b32 v49, 0
  v_mov_b32 v50, 0
  v_mov_b32 v51, 0
  v_mov_b32 v52, 0
  v_mov_b32 v53, 0
  v_mov_b32 v54, 0
  v_mov_b32 v55, 0
  v_mov_b32 v56, 0
  v_mov_b32 v57, 0
  v_mov_b32 v58, 0
  v_mov_b32 v59, 0
  v_mov_b32 v60, 0
  v_mov_b32 v61, 0
  v_mov_b32 v62, 0
  v_mov_b32 v63, 0
  v_mov_b32 v64, 0
  v_mov_b32 v65, 0
  v_mov_b32 v66, 0
  v_mov_b32 v67, 0
  v_mov_b32 v68, 0
  v_mov_b32 v69, 0
  v_mov_b32 v70, 0
  v_mov_b32 v71, 0
  v_mov_b32 v72, 0
  v_mov_b32 v73, 0
  v_mov_b32 v74, 0
  v_mov_b32 v75, 0
  v_mov_b32 v76, 0
  v_mov_b32 v77, 0
  v_mov_b32 v78, 0
  v_mov_b32 v79, 0
  v_mov_b32 v80, 0
  v_mov_b32 v81, 0
  v_mov_b32 v82, 0
  v_mov_b32 v83, 0
  v_mov_b32 v84, 0
  v_mov_b32 v85, 0
  v_mov_b32 v86, 0
  v_mov_b32 v87, 0
  v_mov_b32 v88, 0
  v_mov_b32 v89, 0
  v_mov_b32 v90, 0
  v_mov_b32 v91, 0
  v_mov_b32 v92, 0
  v_mov_b32 v93, 0
  v_mov_b32 v94, 0
  v_mov_b32 v95, 0
  v_mov_b32 v96, 0
  v_mov_b32 v97, 0
  v_mov_b32 v98, 0
  v_mov_b32 v99, 0
  v_mov_b32 v100, 0
  v_mov_b32 v101, 0
  v_mov_b32 v102, 0
  v_mov_b32 v103, 0
  v_mov_b32 v248, 0
  v_mov_b32 v249, 0
  v_mov_b32 v250, 0
  v_mov_b32_e64 v251, 0
  s_waitcnt lgkmcnt(0)
  s_cmp_lg_u32 s50, 0
  s_cbranch_scc1 c_y
  s_waitcnt vmcnt(0)
  s_cmp_lg_u32 s55, 0
  s_cbranch_scc1 c_tagok
  s_mov_b32 s66, 0
c_tag:
  v_readfirstlane_b32 s93, v142
  s_nop 3
  s_cmp_lg_u32 s93, 0
  s_cbranch_scc1 c_tagw
  s_add_u32 s66, s66, 1
  s_cmp_lt_u32 s66, 65536
  s_cbranch_scc0 c_tagw
  s_sleep 1
  buffer_load_dword v142, v143, s[80:83], 0 offen sc1
  s_waitcnt vmcnt(0)
  s_branch c_tag
c_tagw:
  v_mov_b32 v143, 156304
  v_mov_b32_e64 v142, s93
  ds_write_b32 v143, v142
  s_waitcnt lgkmcnt(0)
c_tagok:
  v_lshlrev_b32 v128, 16, v104
  v_and_b32 v129, 0xffff0000, v104
  v_mov_b32 v120, v128
  v_mov_b32 v121, v129
  v_pk_mul_f32 v[122:123], v[128:129], v[128:129]
  v_lshlrev_b32_e64 v130, 16, v105
  v_and_b32 v131, 0xffff0000, v105
  v_pk_add_f32 v[120:121], v[120:121], v[130:131]
  v_pk_fma_f32 v[122:123], v[130:131], v[130:131], v[122:123]
  v_lshlrev_b32_e64 v128, 16, v106
  v_and_b32 v129, 0xffff0000, v106
  v_pk_add_f32 v[120:121], v[120:121], v[128:129]
  v_pk_fma_f32 v[122:123], v[128:129], v[128:129], v[122:123]
  v_lshlrev_b32_e64 v130, 16, v107
  v_and_b32 v131, 0xffff0000, v107
  v_pk_add_f32 v[120:121], v[120:121], v[130:131]
  v_pk_fma_f32 v[122:123], v[130:131], v[130:131], v[122:123]
  v_lshlrev_b32_e64 v128, 16, v108
  v_and_b32 v129, 0xffff0000, v108
  v_pk_add_f32 v[120:121], v[120:121], v[128:129]
  v_pk_fma_f32 v[122:123], v[128:129], v[128:129], v[122:123]
  v_lshlrev_b32_e64 v130, 16, v109
  v_and_b32 v131, 0xffff0000, v109
  v_pk_add_f32 v[120:121], v[120:121], v[130:131]
  v_pk_fma_f32 v[122:123], v[130:131], v[130:131], v[122:123]
  v_lshlrev_b32_e64 v128, 16, v110
  v_and_b32 v129, 0xffff0000, v110
  v_pk_add_f32 v[120:121], v[120:121], v[128:129]
  v_pk_fma_f32 v[122:123], v[128:129], v[128:129], v[122:123]
  v_lshlrev_b32_e64 v130, 16, v111
  v_and_b32 v131, 0xffff0000, v111
  v_pk_add_f32 v[120:121], v[120:121], v[130:131]
  v_pk_fma_f32 v[122:123], v[130:131], v[130:131], v[122:123]
  v_lshlrev_b32_e64 v128, 16, v112
  v_and_b32 v129, 0xffff0000, v112
  v_mov_b32 v124, v128
  v_mov_b32 v125, v129
  v_pk_mul_f32 v[126:127], v[128:129], v[128:129]
  v_lshlrev_b32_e64 v130, 16, v113
  v_and_b32 v131, 0xffff0000, v113
  v_pk_add_f32 v[124:125], v[124:125], v[130:131]
  v_pk_fma_f32 v[126:127], v[130:131], v[130:131], v[126:127]
  v_lshlrev_b32_e64 v128, 16, v114
  v_and_b32 v129, 0xffff0000, v114
  v_pk_add_f32 v[124:125], v[124:125], v[128:129]
  v_pk_fma_f32 v[126:127], v[128:129], v[128:129], v[126:127]
  v_lshlrev_b32_e64 v130, 16, v115
  v_and_b32 v131, 0xffff0000, v115
  v_pk_add_f32 v[124:125], v[124:125], v[130:131]
  v_pk_fma_f32 v[126:127], v[130:131], v[130:131], v[126:127]
  v_lshlrev_b32_e64 v128, 16, v116
  v_and_b32 v129, 0xffff0000, v116
  v_pk_add_f32 v[124:125], v[124:125], v[128:129]
  v_pk_fma_f32 v[126:127], v[128:129], v[128:129], v[126:127]
  v_lshlrev_b32_e64 v130, 16, v117
  v_and_b32 v131, 0xffff0000, v117
  v_pk_add_f32 v[124:125], v[124:125], v[130:131]
  v_pk_fma_f32 v[126:127], v[130:131], v[130:131], v[126:127]
  v_lshlrev_b32_e64 v128, 16, v118
  v_and_b32 v129, 0xffff0000, v118
  v_pk_add_f32 v[124:125], v[124:125], v[128:129]
  v_pk_fma_f32 v[126:127], v[128:129], v[128:129], v[126:127]
  v_lshlrev_b32_e64 v130, 16, v119
  v_and_b32 v131, 0xffff0000, v119
  v_pk_add_f32 v[124:125], v[124:125], v[130:131]
  v_pk_fma_f32 v[126:127], v[130:131], v[130:131], v[126:127]
  v_add_f32 v132, v120, v121
  v_add_f32 v133, v122, v123
  v_add_f32 v134, v124, v125
  v_add_f32 v135, v126, v127
  v_add_f32_dpp v132, v132, v132 quad_perm:[1,0,3,2] row_mask:0xf bank_mask:0xf
  v_add_f32_dpp v133, v133, v133 quad_perm:[1,0,3,2] row_mask:0xf bank_mask:0xf
  v_add_f32_dpp v134, v134, v134 quad_perm:[1,0,3,2] row_mask:0xf bank_mask:0xf
  v_add_f32_dpp v135, v135, v135 quad_perm:[1,0,3,2] row_mask:0xf bank_mask:0xf
  v_add_f32_dpp v132, v132, v132 quad_perm:[2,3,0,1] row_mask:0xf bank_mask:0xf
  v_add_f32_dpp v133, v133, v133 quad_perm:[2,3,0,1] row_mask:0xf bank_mask:0xf
  v_add_f32_dpp v134, v134, v134 quad_perm:[2,3,0,1] row_mask:0xf bank_mask:0xf
  v_add_f32_dpp v135, v135, v135 quad_perm:[2,3,0,1] row_mask:0xf bank_mask:0xf
  v_add_f32_dpp v132, v132, v132 row_half_mirror row_mask:0xf bank_mask:0xf
  v_add_f32_dpp v133, v133, v133 row_half_mirror row_mask:0xf bank_mask:0xf
  v_add_f32_dpp v134, v134, v134 row_half_mirror row_mask:0xf bank_mask:0xf
  v_add_f32_dpp v135, v135, v135 row_half_mirror row_mask:0xf bank_mask:0xf
  v_add_f32_dpp v132, v132, v132 row_mirror row_mask:0xf bank_mask:0xf
  v_add_f32_dpp v133, v133, v133 row_mirror row_mask:0xf bank_mask:0xf
  v_add_f32_dpp v134, v134, v134 row_mirror row_mask:0xf bank_mask:0xf
  v_add_f32_dpp v135, v135, v135 row_mirror row_mask:0xf bank_mask:0xf
  v_mov_b32 v128, v132
  v_mov_b32 v129, v133
  v_mov_b32 v130, v134
  v_mov_b32 v131, v135
  v_permlane32_swap_b32 v132, v128
  v_permlane32_swap_b32 v133, v129
  v_permlane32_swap_b32 v134, v130
  v_permlane32_swap_b32 v135, v131
  v_add_f32 v132, v132, v128
  v_add_f32 v133, v133, v129
  v_add_f32 v134, v134, v130
  v_add_f32 v135, v135, v131
  v_mov_b32 v128, v132
  v_mov_b32 v129, v133
  v_mov_b32 v130, v134
  v_mov_b32 v131, v135
  v_permlane16_swap_b32 v132, v128
  v_permlane16_swap_b32 v133, v129
  v_permlane16_swap_b32 v134, v130
  v_permlane16_swap_b32 v135, v131
  v_add_f32 v132, v132, v128
  v_add_f32 v133, v133, v129
  v_add_f32 v134, v134, v130
  v_add_f32 v135, v135, v131
  v_mov_b32_e64 v129, 0
  s_lshl_b32 s57, s2, 6
  s_lshl_b32 s58, s55, 4
  s_add_u32 s57, s57, s58
  s_mov_b64 exec, 1
  buffer_store_dwordx4 v[132:135], v129, s[16:19], s57 offen sc1
  s_mov_b64 exec, -1
  s_branch c_noy
c_y:
  s_cmp_lg_u32 s55, 0
  s_cbranch_scc1 c_nox
  v_and_b32_e64 v236, 15, v247
  v_mul_u32_u24 v236, 1024, v236
  s_max_u32 s58, s51, 1
  s_sub_u32 s58, s58, 1
  s_mul_i32 s58, s58, 16384
  s_mul_i32 s57, s51, 16384
  v_add_u32 v237, s58, v236
  v_add_u32 v236, s57, v236
  v_cmp_le_u32 vcc, 16, v247
  s_nop 1
  v_cndmask_b32_e64 v236, v236, v237, vcc
  s_lshl_b32 s67, s50, 1
  s_sub_u32 s67, s67, 1
  s_mul_i32 s67, s67, 262144
  s_and_b32 s57, s51, 7
  s_lshl_b32 s68, 0x1f001f, s57
  s_mov_b32 exec_hi, 0
  s_mov_b32 exec_lo, 0xffffffff
  s_mov_b32 s66, 0
poll_x:
  buffer_load_dword v240, v236, s[32:35], s67 offen sc1
  s_waitcnt vmcnt(0)
  v_cmp_eq_u32_e64 vcc, s93, v240
  s_nop 3
  s_and_b32 s64, vcc_lo, s68
  s_cmp_eq_u32 s64, s68
  s_cbranch_scc1 poll_x_ok
  s_add_u32 s66, s66, 1
  s_cmp_lt_u32 s66, 65536
  s_cbranch_scc0 poll_x_ok
  s_sleep 1
  s_branch poll_x
poll_x_ok:
  s_mov_b64 exec, -1
c_nox:
  s_barrier
c_noy:
  s_cmp_ge_u32 s55, 2
  s_cbranch_scc1 g1c1
g1c0:
  s_cmp_ge_u32 s50, 2
  s_cbranch_scc1 g1c00
g1c01:
  v_and_b32 v196, 15, v247
  v_cmp_eq_u32_e64 vcc, 0, v196
  v_mov_b32 v197, 0x3f803f80
  s_nop 0
  v_cndmask_b32 v196, 0, v197, vcc
  v_mov_b32 v197, v196
  v_mov_b32 v198, v196
  v_mov_b32 v199, v196
  s_barrier
  ds_read_b64_tr_b16 v[124:125], v194 offset:0
  ds_read_b64_tr_b16 v[126:127], v194 offset:512
  ds_read_b64_tr_b16 v[128:129], v195 offset:0
  ds_read_b64_tr_b16 v[130:131], v195 offset:512
  ds_read_b128 v[108:111], v192 offset:2048
  ds_read_b64_tr_b16 v[132:133], v194 offset:8192
  ds_read_b64_tr_b16 v[134:135], v194 offset:8704
  ds_read_b64_tr_b16 v[136:137], v195 offset:8192
  ds_read_b64_tr_b16 v[138:139], v195 offset:8704
  ds_read_b128 v[112:115], v192 offset:4096
  ds_read_b64_tr_b16 v[140:141], v194 offset:16384
  ds_read_b64_tr_b16 v[142:143], v194 offset:16896
  ds_read_b64_tr_b16 v[144:145], v195 offset:16384
  ds_read_b64_tr_b16 v[146:147], v195 offset:16896
  ds_read_b128 v[116:119], v192 offset:6144
  ds_read_b128 v[120:123], v192 offset:8192
  ds_read_b128 v[104:107], v192 offset:0
  s_mov_b32 s70, 0
  s_mov_b32 s71, 0
  s_mov_b32 s72, 4294930432
  s_mov_b32 s73, 18432
  s_mov_b32 s75, 0
  s_mov_b32 s76, 4294893568
  s_mov_b32 s77, 24576
  s_cmp_eq_u32 s71, 2
  s_cselect_b32 s74, s72, s73
  s_cselect_b32 s71, -1, s71
  s_add_u32 s71, s71, 1
  s_cmp_eq_u32 s75, 3
  s_cselect_b32 s78, s76, s77
  s_cselect_b32 s75, -1, s75
  s_add_u32 s75, s75, 1
  s_waitcnt lgkmcnt(0)
g1c01_loop:
  v_mfma_f32_16x16x32_bf16 v[0:3], v[124:127], v[108:111], v[0:3]
  ds_read_b64_tr_b16 v[168:169], v194 offset:4096
  v_mfma_f32_16x16x32_bf16 v[4:7], v[128:131], v[108:111], v[4:7]
  ds_read_b64_tr_b16 v[170:171], v194 offset:4608
  v_mfma_f32_16x16x32_bf16 v[32:35], v[132:135], v[108:111], v[32:35]
  ds_read_b64_tr_b16 v[172:173], v195 offset:4096
  v_mfma_f32_16x16x32_bf16 v[36:39], v[136:139], v[108:111], v[36:39]
  ds_read_b64_tr_b16 v[174:175], v195 offset:4608
  v_mfma_f32_16x16x32_bf16 v[44:47], v[136:139], v[112:115], v[44:47]
  ds_read_b128 v[152:155], v193 offset:2048
  v_mfma_f32_16x16x32_bf16 v[40:43], v[132:135], v[112:115], v[40:43]
  ds_read_b64_tr_b16 v[176:177], v194 offset:12288
  v_mfma_f32_16x16x32_bf16 v[12:15], v[128:131], v[112:115], v[12:15]
  ds_read_b64_tr_b16 v[178:179], v194 offset:12800
  v_mfma_f32_16x16x32_bf16 v[8:11], v[124:127], v[112:115], v[8:11]
  ds_read_b64_tr_b16 v[180:181], v195 offset:12288
  v_mfma_f32_16x16x32_bf16 v[16:19], v[124:127], v[116:119], v[16:19]
  ds_read_b64_tr_b16 v[182:183], v195 offset:12800
  v_mfma_f32_16x16x32_bf16 v[20:23], v[128:131], v[116:119], v[20:23]
  ds_read_b128 v[156:159], v193 offset:4096
  v_mfma_f32_16x16x32_bf16 v[48:51], v[132:135], v[116:119], v[48:51]
  ds_read_b64_tr_b16 v[184:185], v194 offset:20480
  v_mfma_f32_16x16x32_bf16 v[52:55], v[136:139], v[116:119], v[52:55]
  ds_read_b64_tr_b16 v[186:187], v194 offset:20992
  v_mfma_f32_16x16x32_bf16 v[60:63], v[136:139], v[120:123], v[60:63]
  ds_read_b64_tr_b16 v[188:189], v195 offset:20480
  v_mfma_f32_16x16x32_bf16 v[56:59], v[132:135], v[120:123], v[56:59]
  ds_read_b64_tr_b16 v[190:191], v195 offset:20992
  v_mfma_f32_16x16x32_bf16 v[28:31], v[128:131], v[120:123], v[28:31]
  ds_read_b128 v[160:163], v193 offset:6144
  v_mfma_f32_16x16x32_bf16 v[24:27], v[124:127], v[120:123], v[24:27]
  ds_read_b128 v[164:167], v193 offset:8192
  v_mfma_f32_16x16x32_bf16 v[248:251], v[124:127], v[196:199], v[248:251]
  ds_read_b128 v[148:151], v193 offset:0
  v_mfma_f32_16x16x32_bf16 v[96:99], v[132:135], v[104:107], v[96:99]
  v_add_u32_e64 v192, s74, v192
  v_mfma_f32_16x16x32_bf16 v[100:103], v[136:139], v[104:107], v[100:103]
  v_add_u32_e64 v193, s74, v193
  v_mfma_f32_16x16x32_bf16 v[88:91], v[120:123], v[140:143], v[88:91]
  v_add_u32_e64 v194, s78, v194
  v_mfma_f32_16x16x32_bf16 v[92:95], v[120:123], v[144:147], v[92:95]
  v_add_u32_e64 v195, s78, v195
  v_mfma_f32_16x16x32_bf16 v[84:87], v[116:119], v[144:147], v[84:87]
  s_cmp_eq_u32 s70, s89
  s_cbranch_scc1 g1c01_hs
g1c01_hsb:
  v_mfma_f32_16x16x32_bf16 v[80:83], v[116:119], v[140:143], v[80:83]
  v_mfma_f32_16x16x32_bf16 v[72:75], v[112:115], v[140:143], v[72:75]
  s_sub_u32 s57, s70, 6
  v_mfma_f32_16x16x32_bf16 v[76:79], v[112:115], v[144:147], v[76:79]
  s_waitcnt lgkmcnt(0)
  s_cmp_lt_u32 s57, s88
  s_cbranch_scc1 g1c01_wm
g1c01_wmb:
  v_mfma_f32_16x16x32_bf16 v[68:71], v[108:111], v[144:147], v[68:71]
  v_mfma_f32_16x16x32_bf16 v[64:67], v[108:111], v[140:143], v[64:67]
  s_barrier
  v_mfma_f32_16x16x32_bf16 v[0:3], v[168:171], v[152:155], v[0:3]
  ds_read_b64_tr_b16 v[124:125], v194 offset:0
  v_mfma_f32_16x16x32_bf16 v[4:7], v[172:175], v[152:155], v[4:7]
  ds_read_b64_tr_b16 v[126:127], v194 offset:512
  v_mfma_f32_16x16x32_bf16 v[32:35], v[176:179], v[152:155], v[32:35]
  ds_read_b64_tr_b16 v[128:129], v195 offset:0
  v_mfma_f32_16x16x32_bf16 v[36:39], v[180:183], v[152:155], v[36:39]
  ds_read_b64_tr_b16 v[130:131], v195 offset:512
  v_mfma_f32_16x16x32_bf16 v[44:47], v[180:183], v[156:159], v[44:47]
  ds_read_b128 v[108:111], v192 offset:2048
  v_mfma_f32_16x16x32_bf16 v[40:43], v[176:179], v[156:159], v[40:43]
  ds_read_b64_tr_b16 v[132:133], v194 offset:8192
  v_mfma_f32_16x16x32_bf16 v[12:15], v[172:175], v[156:159], v[12:15]
  ds_read_b64_tr_b16 v[134:135], v194 offset:8704
  v_mfma_f32_16x16x32_bf16 v[8:11], v[168:171], v[156:159], v[8:11]
  ds_read_b64_tr_b16 v[136:137], v195 offset:8192
  v_mfma_f32_16x16x32_bf16 v[16:19], v[168:171], v[160:163], v[16:19]
  ds_read_b64_tr_b16 v[138:139], v195 offset:8704
  v_mfma_f32_16x16x32_bf16 v[20:23], v[172:175], v[160:163], v[20:23]
  ds_read_b128 v[112:115], v192 offset:4096
  v_mfma_f32_16x16x32_bf16 v[48:51], v[176:179], v[160:163], v[48:51]
  ds_read_b64_tr_b16 v[140:141], v194 offset:16384
  v_mfma_f32_16x16x32_bf16 v[52:55], v[180:183], v[160:163], v[52:55]
  ds_read_b64_tr_b16 v[142:143], v194 offset:16896
  v_mfma_f32_16x16x32_bf16 v[60:63], v[180:183], v[164:167], v[60:63]
  ds_read_b64_tr_b16 v[144:145], v195 offset:16384
  v_mfma_f32_16x16x32_bf16 v[56:59], v[176:179], v[164:167], v[56:59]
  ds_read_b64_tr_b16 v[146:147], v195 offset:16896
  v_mfma_f32_16x16x32_bf16 v[28:31], v[172:175], v[164:167], v[28:31]
  ds_read_b128 v[116:119], v192 offset:6144
  v_mfma_f32_16x16x32_bf16 v[24:27], v[168:171], v[164:167], v[24:27]
  ds_read_b128 v[120:123], v192 offset:8192
  v_mfma_f32_16x16x32_bf16 v[248:251], v[168:171], v[196:199], v[248:251]
  ds_read_b128 v[104:107], v192 offset:0
  s_cmp_eq_u32 s71, 2
  v_mfma_f32_16x16x32_bf16 v[96:99], v[176:179], v[148:151], v[96:99]
  s_cselect_b32 s74, s72, s73
  v_mfma_f32_16x16x32_bf16 v[100:103], v[180:183], v[148:151], v[100:103]
  s_cselect_b32 s71, -1, s71
  v_mfma_f32_16x16x32_bf16 v[88:91], v[164:167], v[184:187], v[88:91]
  s_add_u32 s71, s71, 1
  v_mfma_f32_16x16x32_bf16 v[92:95], v[164:167], v[188:191], v[92:95]
  s_cmp_eq_u32 s75, 3
  v_mfma_f32_16x16x32_bf16 v[84:87], v[160:163], v[188:191], v[84:87]
  s_cselect_b32 s78, s76, s77
  v_mfma_f32_16x16x32_bf16 v[80:83], v[160:163], v[184:187], v[80:83]
  s_cselect_b32 s75, -1, s75
  v_mfma_f32_16x16x32_bf16 v[72:75], v[156:159], v[184:187], v[72:75]
  s_add_u32 s75, s75, 1
  v_mfma_f32_16x16x32_bf16 v[76:79], v[156:159], v[188:191], v[76:79]
  s_waitcnt lgkmcnt(0)
  s_add_u32 s70, s70, 1
  v_mfma_f32_16x16x32_bf16 v[68:71], v[152:155], v[188:191], v[68:71]
  s_cmp_lt_u32 s70, 15
  v_mfma_f32_16x16x32_bf16 v[64:67], v[152:155], v[184:187], v[64:67]
  s_cbranch_scc1 g1c01_loop
  v_mfma_f32_16x16x32_bf16 v[0:3], v[124:127], v[108:111], v[0:3]
  ds_read_b64_tr_b16 v[168:169], v194 offset:4096
  v_mfma_f32_16x16x32_bf16 v[4:7], v[128:131], v[108:111], v[4:7]
  ds_read_b64_tr_b16 v[170:171], v194 offset:4608
  v_mfma_f32_16x16x32_bf16 v[32:35], v[132:135], v[108:111], v[32:35]
  ds_read_b64_tr_b16 v[172:173], v195 offset:4096
  v_mfma_f32_16x16x32_bf16 v[36:39], v[136:139], v[108:111], v[36:39]
  ds_read_b64_tr_b16 v[174:175], v195 offset:4608
  v_mfma_f32_16x16x32_bf16 v[44:47], v[136:139], v[112:115], v[44:47]
  ds_read_b128 v[152:155], v193 offset:2048
  v_mfma_f32_16x16x32_bf16 v[40:43], v[132:135], v[112:115], v[40:43]
  ds_read_b64_tr_b16 v[176:177], v194 offset:12288
  v_mfma_f32_16x16x32_bf16 v[12:15], v[128:131], v[112:115], v[12:15]
  ds_read_b64_tr_b16 v[178:179], v194 offset:12800
  v_mfma_f32_16x16x32_bf16 v[8:11], v[124:127], v[112:115], v[8:11]
  ds_read_b64_tr_b16 v[180:181], v195 offset:12288
  v_mfma_f32_16x16x32_bf16 v[16:19], v[124:127], v[116:119], v[16:19]
  ds_read_b64_tr_b16 v[182:183], v195 offset:12800
  v_mfma_f32_16x16x32_bf16 v[20:23], v[128:131], v[116:119], v[20:23]
  ds_read_b128 v[156:159], v193 offset:4096
  v_and_b32 v246, 15, v247
  v_mfma_f32_16x16x32_bf16 v[48:51], v[132:135], v[116:119], v[48:51]
  ds_read_b64_tr_b16 v[184:185], v194 offset:20480
  v_lshrrev_b32_e64 v245, 4, v247
  v_mfma_f32_16x16x32_bf16 v[52:55], v[136:139], v[116:119], v[52:55]
  ds_read_b64_tr_b16 v[186:187], v194 offset:20992
  v_lshlrev_b32_e64 v244, 2, v246
  v_mfma_f32_16x16x32_bf16 v[60:63], v[136:139], v[120:123], v[60:63]
  ds_read_b64_tr_b16 v[188:189], v195 offset:20480
  v_lshlrev_b32_e64 v243, 4, v245
  v_mfma_f32_16x16x32_bf16 v[56:59], v[132:135], v[120:123], v[56:59]
  ds_read_b64_tr_b16 v[190:191], v195 offset:20992
  s_lshl_b32 s57, s56, 7
  v_mfma_f32_16x16x32_bf16 v[28:31], v[128:131], v[120:123], v[28:31]
  ds_read_b128 v[160:163], v193 offset:6144
  s_and_b32 s58, s50, 1
  v_mfma_f32_16x16x32_bf16 v[24:27], v[124:127], v[120:123], v[24:27]
  ds_read_b128 v[164:167], v193 offset:8192
  s_mul_i32 s58, s58, 768
  v_mfma_f32_16x16x32_bf16 v[248:251], v[124:127], v[104:107], v[248:251]
  ds_read_b128 v[148:151], v193 offset:0
  s_add_u32 s57, s57, s58
  v_mfma_f32_16x16x32_bf16 v[96:99], v[132:135], v[104:107], v[96:99]
  s_add_u32 s57, s57, 154752
  v_add_u32 v242, s57, v243
  v_mfma_f32_16x16x32_bf16 v[100:103], v[136:139], v[104:107], v[100:103]
  v_add_u32_e64 v241, s57, v244
  v_add_u32 v244, 153600, v244
  v_mfma_f32_16x16x32_bf16 v[88:91], v[120:123], v[140:143], v[88:91]
  v_add_u32 v243, 153600, v243
  s_lshl_b32 s57, s56, 12
  v_mfma_f32_16x16x32_bf16 v[92:95], v[120:123], v[144:147], v[92:95]
  v_lshlrev_b32 v240, 4, v247
  v_add_u32_e64 v240, s57, v240
  v_mfma_f32_16x16x32_bf16 v[84:87], v[116:119], v[144:147], v[84:87]
  v_lshlrev_b32 v239, 3, v247
  v_add_u32 v239, s57, v239
  v_mfma_f32_16x16x32_bf16 v[80:83], v[116:119], v[140:143], v[80:83]
  v_lshlrev_b32 v238, 4, v247
  s_lshl_b32 s57, s51, 4
  v_mfma_f32_16x16x32_bf16 v[72:75], v[112:115], v[140:143], v[72:75]
  s_add_u32 s57, s57, s52
  s_lshl_b32 s57, s57, 14
  v_mfma_f32_16x16x32_bf16 v[76:79], v[112:115], v[144:147], v[76:79]
  s_lshl_b32 s58, s56, 10
  s_add_u32 s57, s57, s58
  v_mfma_f32_16x16x32_bf16 v[68:71], v[108:111], v[144:147], v[68:71]
  s_add_u32 s57, s57, 0
  v_add_u32 v238, s57, v238
  v_mfma_f32_16x16x32_bf16 v[64:67], v[108:111], v[140:143], v[64:67]
  s_mov_b32 s75, 1048744942
  s_movk_i32 s76, 4096
  s_waitcnt lgkmcnt(0)
  s_barrier
g1c01_last:
  v_mfma_f32_16x16x32_bf16 v[0:3], v[168:171], v[152:155], v[0:3]
  ds_read_b32 v104, v244 offset:0
  v_mfma_f32_16x16x32_bf16 v[4:7], v[172:175], v[152:155], v[4:7]
  ds_read_b32 v109, v244 offset:576
  v_mfma_f32_16x16x32_bf16 v[32:35], v[176:179], v[152:155], v[32:35]
  ds_read_b32 v105, v244 offset:64
  v_mfma_f32_16x16x32_bf16 v[36:39], v[180:183], v[152:155], v[36:39]
  ds_read_b32 v110, v244 offset:640
  v_mfma_f32_16x16x32_bf16 v[44:47], v[180:183], v[156:159], v[44:47]
  ds_read_b128 v[200:203], v243 offset:64
  v_mfma_f32_16x16x32_bf16 v[40:43], v[176:179], v[156:159], v[40:43]
  ds_read_b128 v[220:223], v243 offset:640
  v_mfma_f32_16x16x32_bf16 v[12:15], v[172:175], v[156:159], v[12:15]
  ds_read_b32 v106, v244 offset:128
  v_mfma_f32_16x16x32_bf16 v[8:11], v[168:171], v[156:159], v[8:11]
  ds_read_b32 v111, v244 offset:704
  v_mfma_f32_16x16x32_bf16 v[16:19], v[168:171], v[160:163], v[16:19]
  ds_read_b128 v[204:207], v243 offset:128
  v_mfma_f32_16x16x32_bf16 v[20:23], v[172:175], v[160:163], v[20:23]
  ds_read_b128 v[224:227], v243 offset:704
  v_mfma_f32_16x16x32_bf16 v[48:51], v[176:179], v[160:163], v[48:51]
  ds_read_b32 v107, v244 offset:192
  v_mfma_f32_16x16x32_bf16 v[52:55], v[180:183], v[160:163], v[52:55]
  ds_read_b32 v112, v244 offset:768
  v_mfma_f32_16x16x32_bf16 v[60:63], v[180:183], v[164:167], v[60:63]
  ds_read_b128 v[208:211], v243 offset:192
  v_mfma_f32_16x16x32_bf16 v[56:59], v[176:179], v[164:167], v[56:59]
  ds_read_b128 v[228:231], v243 offset:768
  v_mfma_f32_16x16x32_bf16 v[28:31], v[172:175], v[164:167], v[28:31]
  ds_read_b32 v108, v244 offset:256
  v_mfma_f32_16x16x32_bf16 v[24:27], v[168:171], v[164:167], v[24:27]
  ds_read_b32 v113, v244 offset:832
  v_mfma_f32_16x16x32_bf16 v[248:251], v[168:171], v[148:151], v[248:251]
  ds_read_b128 v[212:215], v243 offset:256
  v_mfma_f32_16x16x32_bf16 v[96:99], v[176:179], v[148:151], v[96:99]
  ds_read_b128 v[232:235], v243 offset:832
  v_mfma_f32_16x16x32_bf16 v[100:103], v[180:183], v[148:151], v[100:103]
  v_and_b32 v236, 1, v246
  v_lshlrev_b32_e64 v236, 4, v236
  v_mfma_f32_16x16x32_bf16 v[88:91], v[164:167], v[184:187], v[88:91]
  s_mov_b32 s57, 0x0c0c0100
  v_alignbit_b32 v192, s57, s57, v236
  v_mfma_f32_16x16x32_bf16 v[92:95], v[164:167], v[188:191], v[92:95]
  s_mov_b32 s58, 0x0c0c0302
  v_alignbit_b32 v193, s58, s58, v236
  v_mfma_f32_16x16x32_bf16 v[84:87], v[160:163], v[188:191], v[84:87]
  v_mov_b32 v236, 0x0c0c0c0c
  v_cndmask_b32 v194, v236, v192, s[96:97]
  v_mfma_f32_16x16x32_bf16 v[80:83], v[160:163], v[184:187], v[80:83]
  v_cndmask_b32 v195, v236, v193, s[98:99]
  v_cndmask_b32 v192, v192, v236, s[96:97]
  v_mfma_f32_16x16x32_bf16 v[72:75], v[156:159], v[184:187], v[72:75]
  v_cndmask_b32 v193, v193, v236, s[98:99]
  v_mov_b32 v237, 0xff800000
  v_mfma_f32_16x16x32_bf16 v[76:79], v[156:159], v[188:191], v[76:79]
  s_cmp_eq_u32 s51, 0
  v_mfma_f32_16x16x32_bf16 v[68:71], v[152:155], v[188:191], v[68:71]
  s_cselect_b64 s[60:61], s[96:97], -1
  v_mfma_f32_16x16x32_bf16 v[64:67], v[152:155], v[184:187], v[64:67]
  s_cselect_b64 s[62:63], s[98:99], -1
  s_mov_b32 exec_lo, 0x10001
  s_mov_b32 exec_hi, 0x10001
  ds_write_b128 v242, v[248:251] offset:0
  ds_write_b128 v242, v[96:99] offset:256
  ds_write_b128 v242, v[100:103] offset:320
  s_mov_b64 exec, -1
  v_mov_b32 v248, 0x3f803f80
  v_mov_b32 v249, 0x3f803f80
  v_mov_b32 v250, 0x3f803f80
  v_mov_b32 v251, 0x3f803f80
  s_waitcnt lgkmcnt(0)
  s_barrier
  ds_read_b128 v[114:117], v242 offset:0
  ds_read_b128 v[122:125], v242 offset:256
  ds_read_b32 v130, v241 offset:512
  ds_read_b128 v[118:121], v242 offset:64
  ds_read_b128 v[126:129], v242 offset:320
  ds_read_b32 v131, v241 offset:576
  s_waitcnt lgkmcnt(0)
  s_branch g1e0
g1c01_hs:
  v_mov_b32 v236, 156304
  ds_read_b32 v237, v236
  s_waitcnt vmcnt(0) lgkmcnt(0)
  v_readfirstlane_b32 s93, v237
  v_mov_b32 v236, 156296
  v_mov_b32 v237, 1
  s_mov_b64 exec, 1
  ds_add_rtn_u32 v238, v236, v237
  s_waitcnt lgkmcnt(0)
  v_readfirstlane_b32 s57, v238
  s_nop 3
  s_and_b32 s57, s57, 3
  s_cmp_eq_u32 s57, 3
  s_cbranch_scc0 sig_hs0_skip
  s_lshr_b32 s57, s2, 4
  s_add_u32 s57, s57, 128
  s_mul_i32 s57, s57, 16384
  s_and_b32 s58, s2, 15
  s_mul_i32 s58, s58, 1024
  s_add_u32 s57, s57, s58
  v_mov_b32 v236, 0
  v_mov_b32_e64 v237, s93
  buffer_store_dword v237, v236, s[32:35], s57 offen sc1
sig_hs0_skip:
  s_mov_b64 exec, -1
  s_mov_b32 s89, -1
  s_branch g1c01_hsb
g1c01_wm:
  s_lshl_b32 s58, s2, 2
  s_add_u32 s58, s58, s55
  v_lshlrev_b32 v239, 7, v247
  s_mov_b32 exec_hi, 0
  s_cmp_lg_u32 s57, 0
  s_cbranch_scc1 g1c01_wm1
  s_lshl_b32 s58, s58, 11
  s_mov_b32 exec_lo, 0xffff
  buffer_load_dword v253, v239, s[20:23], s58 offen
  s_branch g1c01_wm2
g1c01_wm1:
  s_mul_i32 s58, s58, 6144
  s_mul_i32 s57, s57, 3072
  s_add_u32 s58, s58, s57
  s_sub_u32 s58, s58, 3072
  s_mov_b32 s60, s44
  s_mov_b32 s61, s45
  s_mov_b32 s62, 6291456
  s_mov_b32 s63, 0x20000
  s_mov_b32 exec_lo, 0xffffff
  buffer_load_dword v253, v239, s[60:63], s58 offen
g1c01_wm2:
  s_mov_b64 exec, -1
  s_branch g1c01_wmb
g1c00:
  s_barrier
  ds_read_b64_tr_b16 v[124:125], v194 offset:0
  ds_read_b64_tr_b16 v[126:127], v194 offset:512
  ds_read_b64_tr_b16 v[128:129], v195 offset:0
  ds_read_b64_tr_b16 v[130:131], v195 offset:512
  ds_read_b128 v[108:111], v192 offset:2048
  ds_read_b64_tr_b16 v[132:133], v194 offset:8192
  ds_read_b64_tr_b16 v[134:135], v194 offset:8704
  ds_read_b64_tr_b16 v[136:137], v195 offset:8192
  ds_read_b64_tr_b16 v[138:139], v195 offset:8704
  ds_read_b128 v[112:115], v192 offset:4096
  ds_read_b64_tr_b16 v[140:141], v194 offset:16384
  ds_read_b64_tr_b16 v[142:143], v194 offset:16896
  ds_read_b64_tr_b16 v[144:145], v195 offset:16384
  ds_read_b64_tr_b16 v[146:147], v195 offset:16896
  ds_read_b128 v[116:119], v192 offset:6144
  ds_read_b128 v[120:123], v192 offset:8192
  ds_read_b128 v[104:107], v192 offset:0
  s_mov_b32 s70, 0
  s_mov_b32 s71, 0
  s_mov_b32 s72, 4294930432
  s_mov_b32 s73, 18432
  s_mov_b32 s75, 0
  s_mov_b32 s76, 4294893568
  s_mov_b32 s77, 24576
  s_cmp_eq_u32 s71, 2
  s_cselect_b32 s74, s72, s73
  s_cselect_b32 s71, -1, s71
  s_add_u32 s71, s71, 1
  s_cmp_eq_u32 s75, 3
  s_cselect_b32 s78, s76, s77
  s_cselect_b32 s75, -1, s75
  s_add_u32 s75, s75, 1
  s_waitcnt lgkmcnt(0)
g1c00_loop:
  v_mfma_f32_16x16x32_bf16 v[36:39], v[136:139], v[108:111], v[36:39]
  ds_read_b64_tr_b16 v[168:169], v194 offset:4096
  v_mfma_f32_16x16x32_bf16 v[32:35], v[132:135], v[108:111], v[32:35]
  ds_read_b64_tr_b16 v[170:171], v194 offset:4608
  v_mfma_f32_16x16x32_bf16 v[4:7], v[128:131], v[108:111], v[4:7]
  ds_read_b64_tr_b16 v[172:173], v195 offset:4096
  v_mfma_f32_16x16x32_bf16 v[0:3], v[124:127], v[108:111], v[0:3]
  ds_read_b64_tr_b16 v[174:175], v195 offset:4608
  v_mfma_f32_16x16x32_bf16 v[8:11], v[124:127], v[112:115], v[8:11]
  ds_read_b128 v[152:155], v193 offset:2048
  v_mfma_f32_16x16x32_bf16 v[12:15], v[128:131], v[112:115], v[12:15]
  ds_read_b64_tr_b16 v[176:177], v194 offset:12288
  v_mfma_f32_16x16x32_bf16 v[40:43], v[132:135], v[112:115], v[40:43]
  ds_read_b64_tr_b16 v[178:179], v194 offset:12800
  v_mfma_f32_16x16x32_bf16 v[44:47], v[136:139], v[112:115], v[44:47]
  ds_read_b64_tr_b16 v[180:181], v195 offset:12288
  v_mfma_f32_16x16x32_bf16 v[52:55], v[136:139], v[116:119], v[52:55]
  ds_read_b64_tr_b16 v[182:183], v195 offset:12800
  v_mfma_f32_16x16x32_bf16 v[48:51], v[132:135], v[116:119], v[48:51]
  ds_read_b128 v[156:159], v193 offset:4096
  v_mfma_f32_16x16x32_bf16 v[20:23], v[128:131], v[116:119], v[20:23]
  ds_read_b64_tr_b16 v[184:185], v194 offset:20480
  v_mfma_f32_16x16x32_bf16 v[16:19], v[124:127], v[116:119], v[16:19]
  ds_read_b64_tr_b16 v[186:187], v194 offset:20992
  v_mfma_f32_16x16x32_bf16 v[24:27], v[124:127], v[120:123], v[24:27]
  ds_read_b64_tr_b16 v[188:189], v195 offset:20480
  v_mfma_f32_16x16x32_bf16 v[28:31], v[128:131], v[120:123], v[28:31]
  ds_read_b64_tr_b16 v[190:191], v195 offset:20992
  v_mfma_f32_16x16x32_bf16 v[56:59], v[132:135], v[120:123], v[56:59]
  ds_read_b128 v[160:163], v193 offset:6144
  v_mfma_f32_16x16x32_bf16 v[60:63], v[136:139], v[120:123], v[60:63]
  ds_read_b128 v[164:167], v193 offset:8192
  v_mfma_f32_16x16x32_bf16 v[100:103], v[136:139], v[104:107], v[100:103]
  ds_read_b128 v[148:151], v193 offset:0
  v_mfma_f32_16x16x32_bf16 v[96:99], v[132:135], v[104:107], v[96:99]
  v_add_u32 v192, s74, v192
  v_mfma_f32_16x16x32_bf16 v[88:91], v[120:123], v[140:143], v[88:91]
  v_add_u32_e64 v193, s74, v193
  v_mfma_f32_16x16x32_bf16 v[92:95], v[120:123], v[144:147], v[92:95]
  v_add_u32_e64 v194, s78, v194
  v_mfma_f32_16x16x32_bf16 v[84:87], v[116:119], v[144:147], v[84:87]
  v_add_u32_e64 v195, s78, v195
  v_mfma_f32_16x16x32_bf16 v[80:83], v[116:119], v[140:143], v[80:83]
  v_mfma_f32_16x16x32_bf16 v[72:75], v[112:115], v[140:143], v[72:75]
  v_mfma_f32_16x16x32_bf16 v[76:79], v[112:115], v[144:147], v[76:79]
  s_waitcnt lgkmcnt(0)
  v_mfma_f32_16x16x32_bf16 v[68:71], v[108:111], v[144:147], v[68:71]
  v_mfma_f32_16x16x32_bf16 v[64:67], v[108:111], v[140:143], v[64:67]
  s_barrier
  v_mfma_f32_16x16x32_bf16 v[36:39], v[180:183], v[152:155], v[36:39]
  ds_read_b64_tr_b16 v[124:125], v194 offset:0
  v_mfma_f32_16x16x32_bf16 v[32:35], v[176:179], v[152:155], v[32:35]
  ds_read_b64_tr_b16 v[126:127], v194 offset:512
  v_mfma_f32_16x16x32_bf16 v[4:7], v[172:175], v[152:155], v[4:7]
  ds_read_b64_tr_b16 v[128:129], v195 offset:0
  v_mfma_f32_16x16x32_bf16 v[0:3], v[168:171], v[152:155], v[0:3]
  ds_read_b64_tr_b16 v[130:131], v195 offset:512
  v_mfma_f32_16x16x32_bf16 v[8:11], v[168:171], v[156:159], v[8:11]
  ds_read_b128 v[108:111], v192 offset:2048
  v_mfma_f32_16x16x32_bf16 v[12:15], v[172:175], v[156:159], v[12:15]
  ds_read_b64_tr_b16 v[132:133], v194 offset:8192
  v_mfma_f32_16x16x32_bf16 v[40:43], v[176:179], v[156:159], v[40:43]
  ds_read_b64_tr_b16 v[134:135], v194 offset:8704
  v_mfma_f32_16x16x32_bf16 v[44:47], v[180:183], v[156:159], v[44:47]
  ds_read_b64_tr_b16 v[136:137], v195 offset:8192
  v_mfma_f32_16x16x32_bf16 v[52:55], v[180:183], v[160:163], v[52:55]
  ds_read_b64_tr_b16 v[138:139], v195 offset:8704
  v_mfma_f32_16x16x32_bf16 v[48:51], v[176:179], v[160:163], v[48:51]
  ds_read_b128 v[112:115], v192 offset:4096
  v_mfma_f32_16x16x32_bf16 v[20:23], v[172:175], v[160:163], v[20:23]
  ds_read_b64_tr_b16 v[140:141], v194 offset:16384
  v_mfma_f32_16x16x32_bf16 v[16:19], v[168:171], v[160:163], v[16:19]
  ds_read_b64_tr_b16 v[142:143], v194 offset:16896
  v_mfma_f32_16x16x32_bf16 v[24:27], v[168:171], v[164:167], v[24:27]
  ds_read_b64_tr_b16 v[144:145], v195 offset:16384
  v_mfma_f32_16x16x32_bf16 v[28:31], v[172:175], v[164:167], v[28:31]
  ds_read_b64_tr_b16 v[146:147], v195 offset:16896
  v_mfma_f32_16x16x32_bf16 v[56:59], v[176:179], v[164:167], v[56:59]
  ds_read_b128 v[116:119], v192 offset:6144
  v_mfma_f32_16x16x32_bf16 v[60:63], v[180:183], v[164:167], v[60:63]
  ds_read_b128 v[120:123], v192 offset:8192
  s_cmp_eq_u32 s71, 2
  v_mfma_f32_16x16x32_bf16 v[100:103], v[180:183], v[148:151], v[100:103]
  ds_read_b128 v[104:107], v192 offset:0
  s_cselect_b32 s74, s72, s73
  v_mfma_f32_16x16x32_bf16 v[96:99], v[176:179], v[148:151], v[96:99]
  s_cselect_b32 s71, -1, s71
  v_mfma_f32_16x16x32_bf16 v[88:91], v[164:167], v[184:187], v[88:91]
  s_add_u32 s71, s71, 1
  v_mfma_f32_16x16x32_bf16 v[92:95], v[164:167], v[188:191], v[92:95]
  s_cmp_eq_u32 s75, 3
  v_mfma_f32_16x16x32_bf16 v[84:87], v[160:163], v[188:191], v[84:87]
  s_cselect_b32 s78, s76, s77
  v_mfma_f32_16x16x32_bf16 v[80:83], v[160:163], v[184:187], v[80:83]
  s_cselect_b32 s75, -1, s75
  v_mfma_f32_16x16x32_bf16 v[72:75], v[156:159], v[184:187], v[72:75]
  s_add_u32 s75, s75, 1
  v_mfma_f32_16x16x32_bf16 v[76:79], v[156:159], v[188:191], v[76:79]
  s_waitcnt lgkmcnt(0)
  s_add_u32 s70, s70, 1
  v_mfma_f32_16x16x32_bf16 v[68:71], v[152:155], v[188:191], v[68:71]
  s_cmp_lt_u32 s70, 15
  v_mfma_f32_16x16x32_bf16 v[64:67], v[152:155], v[184:187], v[64:67]
  s_cbranch_scc1 g1c00_loop
  v_mfma_f32_16x16x32_bf16 v[36:39], v[136:139], v[108:111], v[36:39]
  ds_read_b64_tr_b16 v[168:169], v194 offset:4096
  v_mfma_f32_16x16x32_bf16 v[32:35], v[132:135], v[108:111], v[32:35]
  ds_read_b64_tr_b16 v[170:171], v194 offset:4608
  v_mfma_f32_16x16x32_bf16 v[4:7], v[128:131], v[108:111], v[4:7]
  ds_read_b64_tr_b16 v[172:173], v195 offset:4096
  v_mfma_f32_16x16x32_bf16 v[0:3], v[124:127], v[108:111], v[0:3]
  ds_read_b64_tr_b16 v[174:175], v195 offset:4608
  v_mfma_f32_16x16x32_bf16 v[8:11], v[124:127], v[112:115], v[8:11]
  ds_read_b128 v[152:155], v193 offset:2048
  v_mfma_f32_16x16x32_bf16 v[12:15], v[128:131], v[112:115], v[12:15]
  ds_read_b64_tr_b16 v[176:177], v194 offset:12288
  v_mfma_f32_16x16x32_bf16 v[40:43], v[132:135], v[112:115], v[40:43]
  ds_read_b64_tr_b16 v[178:179], v194 offset:12800
  v_mfma_f32_16x16x32_bf16 v[44:47], v[136:139], v[112:115], v[44:47]
  ds_read_b64_tr_b16 v[180:181], v195 offset:12288
  v_and_b32_e64 v246, 15, v247
  v_mfma_f32_16x16x32_bf16 v[52:55], v[136:139], v[116:119], v[52:55]
  ds_read_b64_tr_b16 v[182:183], v195 offset:12800
  v_lshrrev_b32_e64 v245, 4, v247
  v_mfma_f32_16x16x32_bf16 v[48:51], v[132:135], v[116:119], v[48:51]
  ds_read_b128 v[156:159], v193 offset:4096
  v_lshlrev_b32_e64 v244, 2, v246
  v_mfma_f32_16x16x32_bf16 v[20:23], v[128:131], v[116:119], v[20:23]
  ds_read_b64_tr_b16 v[184:185], v194 offset:20480
  v_lshlrev_b32_e64 v243, 4, v245
  v_mfma_f32_16x16x32_bf16 v[16:19], v[124:127], v[116:119], v[16:19]
  ds_read_b64_tr_b16 v[186:187], v194 offset:20992
  s_lshl_b32 s57, s56, 7
  v_mfma_f32_16x16x32_bf16 v[24:27], v[124:127], v[120:123], v[24:27]
  ds_read_b64_tr_b16 v[188:189], v195 offset:20480
  s_and_b32 s58, s50, 1
  v_mfma_f32_16x16x32_bf16 v[28:31], v[128:131], v[120:123], v[28:31]
  ds_read_b64_tr_b16 v[190:191], v195 offset:20992
  s_mul_i32 s58, s58, 768
  v_mfma_f32_16x16x32_bf16 v[56:59], v[132:135], v[120:123], v[56:59]
  ds_read_b128 v[160:163], v193 offset:6144
  s_add_u32 s57, s57, s58
  v_mfma_f32_16x16x32_bf16 v[60:63], v[136:139], v[120:123], v[60:63]
  ds_read_b128 v[164:167], v193 offset:8192
  s_add_u32 s57, s57, 154752
  v_mfma_f32_16x16x32_bf16 v[100:103], v[136:139], v[104:107], v[100:103]
  ds_read_b128 v[148:151], v193 offset:0
  v_add_u32 v242, s57, v243
  v_mfma_f32_16x16x32_bf16 v[96:99], v[132:135], v[104:107], v[96:99]
  v_add_u32_e64 v241, s57, v244
  v_add_u32 v244, 153600, v244
  v_mfma_f32_16x16x32_bf16 v[88:91], v[120:123], v[140:143], v[88:91]
  v_add_u32 v243, 153600, v243
  s_lshl_b32 s57, s56, 12
  v_mfma_f32_16x16x32_bf16 v[92:95], v[120:123], v[144:147], v[92:95]
  v_lshlrev_b32 v240, 4, v247
  v_add_u32_e64 v240, s57, v240
  v_mfma_f32_16x16x32_bf16 v[84:87], v[116:119], v[144:147], v[84:87]
  v_lshlrev_b32 v239, 3, v247
  v_add_u32 v239, s57, v239
  v_mfma_f32_16x16x32_bf16 v[80:83], v[116:119], v[140:143], v[80:83]
  v_lshlrev_b32 v238, 4, v247
  s_lshl_b32 s57, s51, 4
  v_mfma_f32_16x16x32_bf16 v[72:75], v[112:115], v[140:143], v[72:75]
  s_add_u32 s57, s57, s52
  s_lshl_b32 s57, s57, 14
  v_mfma_f32_16x16x32_bf16 v[76:79], v[112:115], v[144:147], v[76:79]
  s_lshl_b32 s58, s56, 10
  s_add_u32 s57, s57, s58
  v_mfma_f32_16x16x32_bf16 v[68:71], v[108:111], v[144:147], v[68:71]
  s_add_u32 s57, s57, 0
  v_add_u32 v238, s57, v238
  v_mfma_f32_16x16x32_bf16 v[64:67], v[108:111], v[140:143], v[64:67]
  s_mov_b32 s75, 1048744942
  s_movk_i32 s76, 4096
  s_waitcnt lgkmcnt(0)
  s_barrier
g1c00_last:
  v_mfma_f32_16x16x32_bf16 v[36:39], v[180:183], v[152:155], v[36:39]
  ds_read_b32 v104, v244 offset:0
  v_mfma_f32_16x16x32_bf16 v[32:35], v[176:179], v[152:155], v[32:35]
  ds_read_b32 v109, v244 offset:576
  v_mfma_f32_16x16x32_bf16 v[4:7], v[172:175], v[152:155], v[4:7]
  ds_read_b32 v105, v244 offset:64
  v_mfma_f32_16x16x32_bf16 v[0:3], v[168:171], v[152:155], v[0:3]
  ds_read_b32 v110, v244 offset:640
  v_mfma_f32_16x16x32_bf16 v[8:11], v[168:171], v[156:159], v[8:11]
  ds_read_b128 v[200:203], v243 offset:64
  v_mfma_f32_16x16x32_bf16 v[12:15], v[172:175], v[156:159], v[12:15]
  ds_read_b128 v[220:223], v243 offset:640
  v_mfma_f32_16x16x32_bf16 v[40:43], v[176:179], v[156:159], v[40:43]
  ds_read_b32 v106, v244 offset:128
  v_mfma_f32_16x16x32_bf16 v[44:47], v[180:183], v[156:159], v[44:47]
  ds_read_b32 v111, v244 offset:704
  v_mfma_f32_16x16x32_bf16 v[52:55], v[180:183], v[160:163], v[52:55]
  ds_read_b128 v[204:207], v243 offset:128
  v_mfma_f32_16x16x32_bf16 v[48:51], v[176:179], v[160:163], v[48:51]
  ds_read_b128 v[224:227], v243 offset:704
  v_and_b32 v236, 1, v246
  v_mfma_f32_16x16x32_bf16 v[20:23], v[172:175], v[160:163], v[20:23]
  ds_read_b32 v107, v244 offset:192
  v_lshlrev_b32_e64 v236, 4, v236
  v_mfma_f32_16x16x32_bf16 v[16:19], v[168:171], v[160:163], v[16:19]
  ds_read_b32 v112, v244 offset:768
  s_mov_b32 s57, 0x0c0c0100
  v_mfma_f32_16x16x32_bf16 v[24:27], v[168:171], v[164:167], v[24:27]
  ds_read_b128 v[208:211], v243 offset:192
  v_alignbit_b32 v192, s57, s57, v236
  v_mfma_f32_16x16x32_bf16 v[28:31], v[172:175], v[164:167], v[28:31]
  ds_read_b128 v[228:231], v243 offset:768
  s_mov_b32 s58, 0x0c0c0302
  v_mfma_f32_16x16x32_bf16 v[56:59], v[176:179], v[164:167], v[56:59]
  ds_read_b32 v108, v244 offset:256
  v_alignbit_b32 v193, s58, s58, v236
  v_mfma_f32_16x16x32_bf16 v[60:63], v[180:183], v[164:167], v[60:63]
  ds_read_b32 v113, v244 offset:832
  v_mov_b32 v236, 0x0c0c0c0c
  v_mfma_f32_16x16x32_bf16 v[100:103], v[180:183], v[148:151], v[100:103]
  ds_read_b128 v[212:215], v243 offset:256
  v_cndmask_b32 v194, v236, v192, s[96:97]
  v_mfma_f32_16x16x32_bf16 v[96:99], v[176:179], v[148:151], v[96:99]
  ds_read_b128 v[232:235], v243 offset:832
  v_cndmask_b32 v195, v236, v193, s[98:99]
  v_mfma_f32_16x16x32_bf16 v[88:91], v[164:167], v[184:187], v[88:91]
  ds_read_b128 v[114:117], v242 offset:0
  v_cndmask_b32 v192, v192, v236, s[96:97]
  v_mfma_f32_16x16x32_bf16 v[92:95], v[164:167], v[188:191], v[92:95]
  ds_read_b128 v[122:125], v242 offset:256
  v_cndmask_b32 v193, v193, v236, s[98:99]
  v_mfma_f32_16x16x32_bf16 v[84:87], v[160:163], v[188:191], v[84:87]
  ds_read_b32 v130, v241 offset:512
  v_mov_b32 v237, 0xff800000
  v_mfma_f32_16x16x32_bf16 v[80:83], v[160:163], v[184:187], v[80:83]
  ds_read_b128 v[118:121], v242 offset:64
  s_cmp_eq_u32 s51, 0
  v_mfma_f32_16x16x32_bf16 v[72:75], v[156:159], v[184:187], v[72:75]
  ds_read_b128 v[126:129], v242 offset:320
  s_cselect_b64 s[60:61], s[96:97], -1
  v_mfma_f32_16x16x32_bf16 v[76:79], v[156:159], v[188:191], v[76:79]
  ds_read_b32 v131, v241 offset:576
  s_cselect_b64 s[62:63], s[98:99], -1
  v_mfma_f32_16x16x32_bf16 v[68:71], v[152:155], v[188:191], v[68:71]
  v_mov_b32 v248, 0x3f803f80
  v_mov_b32 v249, 0x3f803f80
  v_mfma_f32_16x16x32_bf16 v[64:67], v[152:155], v[184:187], v[64:67]
  v_mov_b32 v250, 0x3f803f80
  v_mov_b32 v251, 0x3f803f80
  s_waitcnt lgkmcnt(0)
g1e0:
  v_pk_fma_f32 v[56:57], v[122:123], v[108:109], v[56:57] op_sel:[0,0,0] op_sel_hi:[1,0,1]
  v_pk_mul_f32 v[56:57], v[56:57], v[112:113] op_sel:[0,1] op_sel_hi:[1,1]
  v_pk_fma_f32 v[58:59], v[124:125], v[108:109], v[58:59] op_sel:[0,0,0] op_sel_hi:[1,0,1]
  v_pk_mul_f32 v[58:59], v[58:59], v[112:113] op_sel:[0,1] op_sel_hi:[1,1]
  v_pk_fma_f32 v[60:61], v[126:127], v[108:109], v[60:61] op_sel:[0,0,0] op_sel_hi:[1,0,1]
  v_pk_mul_f32 v[60:61], v[60:61], v[112:113] op_sel:[0,1] op_sel_hi:[1,1]
  v_pk_fma_f32 v[62:63], v[128:129], v[108:109], v[62:63] op_sel:[0,0,0] op_sel_hi:[1,0,1]
  v_pk_mul_f32 v[62:63], v[62:63], v[112:113] op_sel:[0,1] op_sel_hi:[1,1]
  v_cvt_pk_bf16_f32 v164, v56, v57
  v_cvt_pk_bf16_f32 v165, v58, v59
  v_cvt_pk_bf16_f32 v166, v60, v61
  v_cvt_pk_bf16_f32 v167, v62, v63
  v_pk_fma_f32 v[88:89], v[212:213], v[130:131], v[88:89] op_sel:[0,0,0] op_sel_hi:[1,0,1]
  v_pk_mul_f32 v[88:89], v[88:89], v[232:233]
  v_pk_fma_f32 v[90:91], v[214:215], v[130:131], v[90:91] op_sel:[0,0,0] op_sel_hi:[1,0,1]
  v_pk_mul_f32 v[90:91], v[90:91], v[234:235]
  v_pk_fma_f32 v[92:93], v[212:213], v[130:131], v[92:93] op_sel:[0,1,0] op_sel_hi:[1,1,1]
  v_pk_mul_f32 v[92:93], v[92:93], v[232:233]
  v_pk_fma_f32 v[94:95], v[214:215], v[130:131], v[94:95] op_sel:[0,1,0] op_sel_hi:[1,1,1]
  v_pk_mul_f32 v[94:95], v[94:95], v[234:235]
  v_cvt_pk_bf16_f32 v176, v88, v89
  v_cvt_pk_bf16_f32 v177, v90, v91
  v_cvt_pk_bf16_f32 v186, v92, v93
  v_cvt_pk_bf16_f32 v187, v94, v95
  ds_write_b128 v240, v[164:167]
  ds_write_b64 v239, v[176:177] offset:1024
  ds_write_b64 v239, v[186:187] offset:1536
  v_pk_fma_f32 v[96:97], v[122:123], v[104:105], v[96:97] op_sel:[0,0,0] op_sel_hi:[1,0,1]
  v_pk_mul_f32 v[96:97], v[96:97], v[108:109] op_sel:[0,1] op_sel_hi:[1,1]
  v_pk_fma_f32 v[98:99], v[124:125], v[104:105], v[98:99] op_sel:[0,0,0] op_sel_hi:[1,0,1]
  v_pk_mul_f32 v[98:99], v[98:99], v[108:109] op_sel:[0,1] op_sel_hi:[1,1]
  v_pk_fma_f32 v[100:101], v[126:127], v[104:105], v[100:101] op_sel:[0,0,0] op_sel_hi:[1,0,1]
  v_pk_mul_f32 v[100:101], v[100:101], v[108:109] op_sel:[0,1] op_sel_hi:[1,1]
  v_pk_fma_f32 v[102:103], v[128:129], v[104:105], v[102:103] op_sel:[0,0,0] op_sel_hi:[1,0,1]
  v_pk_mul_f32 v[102:103], v[102:103], v[108:109] op_sel:[0,1] op_sel_hi:[1,1]
  v_cvt_pk_bf16_f32 v148, v96, v97
  v_cvt_pk_bf16_f32 v149, v98, v99
  v_cvt_pk_bf16_f32 v150, v100, v101
  v_cvt_pk_bf16_f32 v151, v102, v103
  s_waitcnt lgkmcnt(0)
  s_barrier
  ds_read_b64 v[168:169], v239 offset:2048
  ds_read_b64 v[178:179], v239 offset:2560
  v_pk_fma_f32 v[32:33], v[122:123], v[104:105], v[32:33] op_sel:[0,1,0] op_sel_hi:[1,1,1]
  v_pk_mul_f32 v[32:33], v[32:33], v[110:111] op_sel:[0,0] op_sel_hi:[1,0]
  v_pk_fma_f32 v[34:35], v[124:125], v[104:105], v[34:35] op_sel:[0,1,0] op_sel_hi:[1,1,1]
  v_pk_mul_f32 v[34:35], v[34:35], v[110:111] op_sel:[0,0] op_sel_hi:[1,0]
  v_pk_fma_f32 v[36:37], v[126:127], v[104:105], v[36:37] op_sel:[0,1,0] op_sel_hi:[1,1,1]
  v_pk_mul_f32 v[36:37], v[36:37], v[110:111] op_sel:[0,0] op_sel_hi:[1,0]
  v_pk_fma_f32 v[38:39], v[128:129], v[104:105], v[38:39] op_sel:[0,1,0] op_sel_hi:[1,1,1]
  v_pk_mul_f32 v[38:39], v[38:39], v[110:111] op_sel:[0,0] op_sel_hi:[1,0]
  v_cvt_pk_bf16_f32 v152, v32, v33
  v_cvt_pk_bf16_f32 v153, v34, v35
  v_cvt_pk_bf16_f32 v154, v36, v37
  v_cvt_pk_bf16_f32 v155, v38, v39
  v_pk_fma_f32 v[40:41], v[122:123], v[106:107], v[40:41] op_sel:[0,0,0] op_sel_hi:[1,0,1]
  v_pk_mul_f32 v[40:41], v[40:41], v[110:111] op_sel:[0,1] op_sel_hi:[1,1]
  v_pk_fma_f32 v[42:43], v[124:125], v[106:107], v[42:43] op_sel:[0,0,0] op_sel_hi:[1,0,1]
  v_pk_mul_f32 v[42:43], v[42:43], v[110:111] op_sel:[0,1] op_sel_hi:[1,1]
  v_pk_fma_f32 v[44:45], v[126:127], v[106:107], v[44:45] op_sel:[0,0,0] op_sel_hi:[1,0,1]
  v_pk_mul_f32 v[44:45], v[44:45], v[110:111] op_sel:[0,1] op_sel_hi:[1,1]
  v_pk_fma_f32 v[46:47], v[128:129], v[106:107], v[46:47] op_sel:[0,0,0] op_sel_hi:[1,0,1]
  v_pk_mul_f32 v[46:47], v[46:47], v[110:111] op_sel:[0,1] op_sel_hi:[1,1]
  v_cvt_pk_bf16_f32 v156, v40, v41
  v_cvt_pk_bf16_f32 v157, v42, v43
  v_cvt_pk_bf16_f32 v158, v44, v45
  v_cvt_pk_bf16_f32 v159, v46, v47
  v_pk_fma_f32 v[8:9], v[114:115], v[106:107], v[8:9] op_sel:[0,0,0] op_sel_hi:[1,0,1]
  v_pk_fma_f32 v[10:11], v[116:117], v[106:107], v[10:11] op_sel:[0,0,0] op_sel_hi:[1,0,1]
  v_pk_fma_f32 v[12:13], v[118:119], v[106:107], v[12:13] op_sel:[0,0,0] op_sel_hi:[1,0,1]
  v_pk_fma_f32 v[14:15], v[120:121], v[106:107], v[14:15] op_sel:[0,0,0] op_sel_hi:[1,0,1]
  v_cvt_pk_bf16_f32 v136, v8, v9
  v_cvt_pk_bf16_f32 v137, v10, v11
  v_cvt_pk_bf16_f32 v138, v12, v13
  v_cvt_pk_bf16_f32 v139, v14, v15
  v_pk_fma_f32 v[48:49], v[122:123], v[106:107], v[48:49] op_sel:[0,1,0] op_sel_hi:[1,1,1]
  v_pk_mul_f32 v[48:49], v[48:49], v[112:113] op_sel:[0,0] op_sel_hi:[1,0]
  v_pk_fma_f32 v[50:51], v[124:125], v[106:107], v[50:51] op_sel:[0,1,0] op_sel_hi:[1,1,1]
  v_pk_mul_f32 v[50:51], v[50:51], v[112:113] op_sel:[0,0] op_sel_hi:[1,0]
  v_pk_fma_f32 v[52:53], v[126:127], v[106:107], v[52:53] op_sel:[0,1,0] op_sel_hi:[1,1,1]
  v_pk_mul_f32 v[52:53], v[52:53], v[112:113] op_sel:[0,0] op_sel_hi:[1,0]
  v_pk_fma_f32 v[54:55], v[128:129], v[106:107], v[54:55] op_sel:[0,1,0] op_sel_hi:[1,1,1]
  v_pk_mul_f32 v[54:55], v[54:55], v[112:113] op_sel:[0,0] op_sel_hi:[1,0]
  v_cvt_pk_bf16_f32 v160, v48, v49
  v_cvt_pk_bf16_f32 v161, v50, v51
  v_cvt_pk_bf16_f32 v162, v52, v53
  v_cvt_pk_bf16_f32 v163, v54, v55
  v_pk_fma_f32 v[16:17], v[114:115], v[106:107], v[16:17] op_sel:[0,1,0] op_sel_hi:[1,1,1]
  v_pk_fma_f32 v[18:19], v[116:117], v[106:107], v[18:19] op_sel:[0,1,0] op_sel_hi:[1,1,1]
  v_pk_fma_f32 v[20:21], v[118:119], v[106:107], v[20:21] op_sel:[0,1,0] op_sel_hi:[1,1,1]
  v_pk_fma_f32 v[22:23], v[120:121], v[106:107], v[22:23] op_sel:[0,1,0] op_sel_hi:[1,1,1]
  v_cvt_pk_bf16_f32 v140, v16, v17
  v_cvt_pk_bf16_f32 v141, v18, v19
  v_cvt_pk_bf16_f32 v142, v20, v21
  v_cvt_pk_bf16_f32 v143, v22, v23
  v_pk_fma_f32 v[24:25], v[114:115], v[108:109], v[24:25] op_sel:[0,0,0] op_sel_hi:[1,0,1]
  v_pk_fma_f32 v[26:27], v[116:117], v[108:109], v[26:27] op_sel:[0,0,0] op_sel_hi:[1,0,1]
  v_pk_fma_f32 v[28:29], v[118:119], v[108:109], v[28:29] op_sel:[0,0,0] op_sel_hi:[1,0,1]
  v_pk_fma_f32 v[30:31], v[120:121], v[108:109], v[30:31] op_sel:[0,0,0] op_sel_hi:[1,0,1]
  v_cvt_pk_bf16_f32 v144, v24, v25
  v_cvt_pk_bf16_f32 v145, v26, v27
  v_cvt_pk_bf16_f32 v146, v28, v29
  v_cvt_pk_bf16_f32 v147, v30, v31
  v_pk_fma_f32 v[0:1], v[114:115], v[104:105], v[0:1] op_sel:[0,1,0] op_sel_hi:[1,1,1]
  v_pk_fma_f32 v[2:3], v[116:117], v[104:105], v[2:3] op_sel:[0,1,0] op_sel_hi:[1,1,1]
  v_pk_fma_f32 v[4:5], v[118:119], v[104:105], v[4:5] op_sel:[0,1,0] op_sel_hi:[1,1,1]
  v_pk_fma_f32 v[6:7], v[120:121], v[104:105], v[6:7] op_sel:[0,1,0] op_sel_hi:[1,1,1]
  v_cvt_pk_bf16_f32 v132, v0, v1
  v_cvt_pk_bf16_f32 v133, v2, v3
  v_cvt_pk_bf16_f32 v134, v4, v5
  v_cvt_pk_bf16_f32 v135, v6, v7
  v_mul_f32 v189, s75, v111
  v_mul_f32 v190, s75, v112
  v_mul_f32 v191, s75, v113
  v_mul_f32 v188, s75, v110
  v_pk_fma_f32 v[64:65], v[200:201], v[130:131], v[64:65] op_sel:[0,0,0] op_sel_hi:[1,0,1]
  v_pk_mul_f32 v[64:65], v[64:65], v[220:221]
  v_pk_fma_f32 v[66:67], v[202:203], v[130:131], v[66:67] op_sel:[0,0,0] op_sel_hi:[1,0,1]
  v_pk_mul_f32 v[66:67], v[66:67], v[222:223]
  v_pk_fma_f32 v[68:69], v[200:201], v[130:131], v[68:69] op_sel:[0,1,0] op_sel_hi:[1,1,1]
  v_pk_mul_f32 v[68:69], v[68:69], v[220:221]
  v_pk_fma_f32 v[70:71], v[202:203], v[130:131], v[70:71] op_sel:[0,1,0] op_sel_hi:[1,1,1]
  v_pk_mul_f32 v[70:71], v[70:71], v[222:223]
  s_waitcnt lgkmcnt(0)
  v_mfma_f32_16x16x32_bf16 v[8:11], v[152:155], v[136:139], 0
  v_cvt_pk_bf16_f32 v170, v64, v65
  v_cvt_pk_bf16_f32 v171, v66, v67
  v_mfma_f32_16x16x32_bf16 v[12:15], v[156:159], v[136:139], 0
  v_cvt_pk_bf16_f32 v180, v68, v69
  v_cvt_pk_bf16_f32 v181, v70, v71
  v_mfma_f32_16x16x32_bf16 v[16:19], v[156:159], v[140:143], 0
  s_nop 1
  v_cndmask_b32 v8, v8, v9, s[94:95]
  v_mfma_f32_16x16x32_bf16 v[20:23], v[160:163], v[140:143], 0
  v_cndmask_b32 v10, v10, v11, s[94:95]
  v_mfma_f32_16x16x32_bf16 v[24:27], v[160:163], v[144:147], 0
  v_cndmask_b32 v12, v12, v13, s[94:95]
  v_cndmask_b32 v14, v14, v15, s[94:95]
  v_mfma_f32_16x16x32_bf16 v[28:31], v[164:167], v[144:147], 0
  v_cndmask_b32 v8, v8, v12, s[96:97]
  v_cndmask_b32 v10, v10, v14, s[98:99]
  v_mfma_f32_16x16x32_bf16 v[0:3], v[148:151], v[132:135], 0
  v_max_f32_e64 v9, v8, v10
  v_cndmask_b32 v16, v16, v17, s[94:95]
  v_mfma_f32_16x16x32_bf16 v[4:7], v[152:155], v[132:135], 0
  v_cndmask_b32 v18, v18, v19, s[94:95]
  v_cndmask_b32 v20, v20, v21, s[94:95]
  v_cndmask_b32 v22, v22, v23, s[94:95]
  v_cndmask_b32 v16, v16, v20, s[96:97]
  v_cndmask_b32 v18, v18, v22, s[98:99]
  v_max_f32_e64 v17, v16, v18
  v_cndmask_b32 v24, v24, v25, s[94:95]
  v_cndmask_b32 v26, v26, v27, s[94:95]
  v_cndmask_b32 v28, v28, v29, s[94:95]
  v_cndmask_b32 v30, v30, v31, s[94:95]
  v_cndmask_b32 v24, v24, v28, s[96:97]
  v_cndmask_b32 v26, v26, v30, s[98:99]
  v_max_f32_e64 v25, v24, v26
  v_cndmask_b32 v0, v0, v1, s[94:95]
  v_cndmask_b32 v2, v2, v3, s[94:95]
  v_cndmask_b32 v4, v4, v5, s[94:95]
  v_cndmask_b32 v6, v6, v7, s[94:95]
  v_cndmask_b32 v0, v0, v4, s[96:97]
  v_cndmask_b32 v2, v2, v6, s[98:99]
  v_cndmask_b32 v0, v237, v0, s[60:61]
  v_cndmask_b32 v2, v237, v2, s[62:63]
  v_max_f32 v1, v0, v2
  v_permlane32_swap_b32 v9, v17
  v_pk_fma_f32 v[72:73], v[204:205], v[130:131], v[72:73] op_sel:[0,0,0] op_sel_hi:[1,0,1]
  v_pk_mul_f32 v[72:73], v[72:73], v[224:225]
  v_permlane32_swap_b32_e64 v25, v1
  v_pk_fma_f32 v[74:75], v[206:207], v[130:131], v[74:75] op_sel:[0,0,0] op_sel_hi:[1,0,1]
  v_pk_mul_f32 v[74:75], v[74:75], v[226:227]
  v_max_f32_e64 v9, v9, v17
  v_pk_fma_f32 v[76:77], v[204:205], v[130:131], v[76:77] op_sel:[0,1,0] op_sel_hi:[1,1,1]
  v_pk_mul_f32 v[76:77], v[76:77], v[224:225]
  v_max_f32_e64 v25, v25, v1
  v_pk_fma_f32 v[78:79], v[206:207], v[130:131], v[78:79] op_sel:[0,1,0] op_sel_hi:[1,1,1]
  v_pk_mul_f32 v[78:79], v[78:79], v[226:227]
  v_permlane16_swap_b32_e64 v9, v25
  v_pk_fma_f32 v[80:81], v[208:209], v[130:131], v[80:81] op_sel:[0,0,0] op_sel_hi:[1,0,1]
  v_pk_mul_f32 v[80:81], v[80:81], v[228:229]
  v_max_f32_e64 v9, v9, v25
  v_pk_fma_f32 v[82:83], v[210:211], v[130:131], v[82:83] op_sel:[0,0,0] op_sel_hi:[1,0,1]
  v_pk_mul_f32 v[82:83], v[82:83], v[230:231]
  v_mov_b32_e64 v17, v9
  v_pk_fma_f32 v[84:85], v[208:209], v[130:131], v[84:85] op_sel:[0,1,0] op_sel_hi:[1,1,1]
  v_pk_mul_f32 v[84:85], v[84:85], v[228:229]
  v_permlane32_swap_b32_e64 v9, v17
  v_pk_fma_f32 v[86:87], v[210:211], v[130:131], v[86:87] op_sel:[0,1,0] op_sel_hi:[1,1,1]
  v_pk_mul_f32 v[86:87], v[86:87], v[230:231]
  v_mov_b32_e64 v25, v9
  v_cvt_pk_bf16_f32 v172, v72, v73
  v_cvt_pk_bf16_f32 v173, v74, v75
  v_mov_b32_e64 v1, v17
  v_cvt_pk_bf16_f32 v182, v76, v77
  v_cvt_pk_bf16_f32 v183, v78, v79
  v_permlane16_swap_b32_e64 v9, v25
  v_cvt_pk_bf16_f32 v174, v80, v81
  v_cvt_pk_bf16_f32 v175, v82, v83
  v_permlane16_swap_b32_e64 v17, v1
  v_cvt_pk_bf16_f32 v184, v84, v85
  v_cvt_pk_bf16_f32 v185, v86, v87
  v_mul_f32 v12, v9, v189
  v_mul_f32 v20, v17, v190
  v_mul_f32 v28, v25, v191
  v_mul_f32 v4, v1, v188
  v_fma_f32 v8, v8, v189, -v12
  v_fma_f32 v10, v10, v189, -v12
  v_fma_f32 v16, v16, v190, -v20
  v_fma_f32 v18, v18, v190, -v20
  v_fma_f32 v24, v24, v191, -v28
  v_fma_f32 v26, v26, v191, -v28
  v_fma_f32 v0, v0, v188, -v4
  v_fma_f32 v2, v2, v188, -v4
  v_exp_f32 v8, v8
  v_exp_f32 v10, v10
  v_exp_f32 v16, v16
  v_exp_f32 v18, v18
  v_exp_f32 v24, v24
  v_exp_f32 v26, v26
  v_exp_f32 v0, v0
  v_exp_f32 v2, v2
  v_cvt_pk_bf16_f32 v13, v8, v10
  v_cvt_pk_bf16_f32 v21, v16, v18
  v_cvt_pk_bf16_f32 v29, v24, v26
  v_cvt_pk_bf16_f32 v5, v0, v2
  v_perm_b32 v40, v13, v13, v192
  v_perm_b32 v41, v13, v13, v193
  v_perm_b32 v42, v13, v13, v194
  v_perm_b32 v43, v13, v13, v195
  v_perm_b32 v48, v21, v21, v192
  v_perm_b32 v49, v21, v21, v193
  v_mfma_f32_16x16x32_bf16 v[12:15], v[248:251], v[40:43], 0
  v_perm_b32 v50, v21, v21, v194
  v_perm_b32 v51, v21, v21, v195
  v_mfma_f32_16x16x32_bf16 v[72:75], v[170:173], v[40:43], 0
  v_perm_b32 v56, v29, v29, v192
  v_perm_b32 v57, v29, v29, v193
  v_mfma_f32_16x16x32_bf16 v[76:79], v[180:183], v[40:43], 0
  v_perm_b32 v58, v29, v29, v194
  v_perm_b32 v59, v29, v29, v195
  v_mfma_f32_16x16x32_bf16 v[20:23], v[248:251], v[48:51], 0
  v_rcp_f32_e64 v12, v12
  v_mfma_f32_16x16x32_bf16 v[80:83], v[172:175], v[48:51], 0
  v_perm_b32 v32, v5, v5, v192
  v_perm_b32 v33, v5, v5, v193
  v_mfma_f32_16x16x32_bf16 v[84:87], v[182:185], v[48:51], 0
  v_perm_b32 v34, v5, v5, v194
  v_perm_b32 v35, v5, v5, v195
  v_mfma_f32_16x16x32_bf16 v[28:31], v[248:251], v[56:59], 0
  v_rcp_f32_e64 v20, v20
  v_mfma_f32_16x16x32_bf16 v[88:91], v[174:177], v[56:59], 0
  v_mfma_f32_16x16x32_bf16 v[92:95], v[184:187], v[56:59], 0
  v_mfma_f32_16x16x32_bf16 v[4:7], v[248:251], v[32:35], 0
  v_mfma_f32_16x16x32_bf16 v[64:67], v[168:171], v[32:35], 0
  v_mfma_f32_16x16x32_bf16 v[68:71], v[178:181], v[32:35], 0
  s_nop 1
  v_rcp_f32 v28, v28
  v_pk_mul_f32 v[72:73], v[72:73], v[12:13] op_sel:[0,0] op_sel_hi:[1,0]
  v_pk_mul_f32 v[74:75], v[74:75], v[12:13] op_sel:[0,0] op_sel_hi:[1,0]
  v_pk_mul_f32 v[76:77], v[76:77], v[12:13] op_sel:[0,0] op_sel_hi:[1,0]
  v_pk_mul_f32 v[78:79], v[78:79], v[12:13] op_sel:[0,0] op_sel_hi:[1,0]
  v_cvt_pk_bf16_f32 v44, v72, v73
  v_rcp_f32_e64 v4, v4
  v_cvt_pk_bf16_f32 v45, v74, v75
  v_cvt_pk_bf16_f32 v46, v76, v77
  v_cvt_pk_bf16_f32 v47, v78, v79
  buffer_store_dwordx4 v[44:47], v238, s[12:15], 0 offen offset:2048 sc1
  v_pk_mul_f32 v[80:81], v[80:81], v[20:21] op_sel:[0,0] op_sel_hi:[1,0]
  v_pk_mul_f32 v[82:83], v[82:83], v[20:21] op_sel:[0,0] op_sel_hi:[1,0]
  v_pk_mul_f32 v[84:85], v[84:85], v[20:21] op_sel:[0,0] op_sel_hi:[1,0]
  v_pk_mul_f32 v[86:87], v[86:87], v[20:21] op_sel:[0,0] op_sel_hi:[1,0]
  v_cvt_pk_bf16_f32 v52, v80, v81
  v_cvt_pk_bf16_f32 v53, v82, v83
  v_cvt_pk_bf16_f32 v54, v84, v85
  v_cvt_pk_bf16_f32 v55, v86, v87
  buffer_store_dwordx4 v[52:55], v238, s[12:15], s76 offen offset:0 sc1
  v_pk_mul_f32 v[88:89], v[88:89], v[28:29] op_sel:[0,0] op_sel_hi:[1,0]
  v_pk_mul_f32 v[90:91], v[90:91], v[28:29] op_sel:[0,0] op_sel_hi:[1,0]
  v_pk_mul_f32 v[92:93], v[92:93], v[28:29] op_sel:[0,0] op_sel_hi:[1,0]
  v_pk_mul_f32 v[94:95], v[94:95], v[28:29] op_sel:[0,0] op_sel_hi:[1,0]
  v_cvt_pk_bf16_f32 v60, v88, v89
  v_cvt_pk_bf16_f32 v61, v90, v91
  v_cvt_pk_bf16_f32 v62, v92, v93
  v_cvt_pk_bf16_f32 v63, v94, v95
  buffer_store_dwordx4 v[60:63], v238, s[12:15], s76 offen offset:2048 sc1
  v_pk_mul_f32 v[64:65], v[64:65], v[4:5] op_sel:[0,0] op_sel_hi:[1,0]
  v_pk_mul_f32 v[66:67], v[66:67], v[4:5] op_sel:[0,0] op_sel_hi:[1,0]
  v_pk_mul_f32 v[68:69], v[68:69], v[4:5] op_sel:[0,0] op_sel_hi:[1,0]
  v_pk_mul_f32 v[70:71], v[70:71], v[4:5] op_sel:[0,0] op_sel_hi:[1,0]
  v_cvt_pk_bf16_f32 v36, v64, v65
  v_cvt_pk_bf16_f32 v37, v66, v67
  v_cvt_pk_bf16_f32 v38, v68, v69
  v_cvt_pk_bf16_f32 v39, v70, v71
  buffer_store_dwordx4 v[36:39], v238, s[12:15], 0 offen offset:0 sc1
  s_branch c_g2
g1c1:
  s_cmp_ge_u32 s50, 2
  s_cbranch_scc1 g1c10
g1c11:
  v_and_b32 v196, 15, v247
  v_cmp_eq_u32_e64 vcc, 0, v196
  v_mov_b32 v197, 0x3f803f80
  s_nop 0
  v_cndmask_b32 v196, 0, v197, vcc
  v_mov_b32 v197, v196
  v_mov_b32 v198, v196
  v_mov_b32 v199, v196
  s_barrier
  ds_read_b64_tr_b16 v[124:125], v194 offset:0
  ds_read_b64_tr_b16 v[126:127], v194 offset:512
  ds_read_b64_tr_b16 v[128:129], v195 offset:0
  ds_read_b64_tr_b16 v[130:131], v195 offset:512
  ds_read_b128 v[108:111], v192 offset:10240
  ds_read_b64_tr_b16 v[132:133], v194 offset:8192
  ds_read_b64_tr_b16 v[134:135], v194 offset:8704
  ds_read_b64_tr_b16 v[136:137], v195 offset:8192
  ds_read_b64_tr_b16 v[138:139], v195 offset:8704
  ds_read_b128 v[112:115], v192 offset:12288
  ds_read_b64_tr_b16 v[140:141], v194 offset:16384
  ds_read_b64_tr_b16 v[142:143], v194 offset:16896
  ds_read_b64_tr_b16 v[144:145], v195 offset:16384
  ds_read_b64_tr_b16 v[146:147], v195 offset:16896
  ds_read_b128 v[116:119], v192 offset:14336
  ds_read_b128 v[120:123], v192 offset:16384
  ds_read_b128 v[104:107], v192 offset:0
  s_mov_b32 s70, 0
  s_mov_b32 s71, 0
  s_mov_b32 s72, 4294930432
  s_mov_b32 s73, 18432
  s_mov_b32 s75, 0
  s_mov_b32 s76, 4294893568
  s_mov_b32 s77, 24576
  s_cmp_eq_u32 s71, 2
  s_cselect_b32 s74, s72, s73
  s_cselect_b32 s71, -1, s71
  s_add_u32 s71, s71, 1
  s_cmp_eq_u32 s75, 3
  s_cselect_b32 s78, s76, s77
  s_cselect_b32 s75, -1, s75
  s_add_u32 s75, s75, 1
  s_waitcnt lgkmcnt(0)
g1c11_loop:
  v_mfma_f32_16x16x32_bf16 v[4:7], v[128:131], v[108:111], v[4:7]
  ds_read_b64_tr_b16 v[168:169], v194 offset:4096
  v_mfma_f32_16x16x32_bf16 v[0:3], v[124:127], v[108:111], v[0:3]
  ds_read_b64_tr_b16 v[170:171], v194 offset:4608
  v_mfma_f32_16x16x32_bf16 v[32:35], v[132:135], v[108:111], v[32:35]
  ds_read_b64_tr_b16 v[172:173], v195 offset:4096
  v_mfma_f32_16x16x32_bf16 v[36:39], v[136:139], v[108:111], v[36:39]
  ds_read_b64_tr_b16 v[174:175], v195 offset:4608
  v_mfma_f32_16x16x32_bf16 v[44:47], v[136:139], v[112:115], v[44:47]
  ds_read_b128 v[152:155], v193 offset:10240
  v_mfma_f32_16x16x32_bf16 v[40:43], v[132:135], v[112:115], v[40:43]
  ds_read_b64_tr_b16 v[176:177], v194 offset:12288
  v_mfma_f32_16x16x32_bf16 v[8:11], v[124:127], v[112:115], v[8:11]
  ds_read_b64_tr_b16 v[178:179], v194 offset:12800
  v_mfma_f32_16x16x32_bf16 v[12:15], v[128:131], v[112:115], v[12:15]
  ds_read_b64_tr_b16 v[180:181], v195 offset:12288
  v_mfma_f32_16x16x32_bf16 v[20:23], v[128:131], v[116:119], v[20:23]
  ds_read_b64_tr_b16 v[182:183], v195 offset:12800
  v_mfma_f32_16x16x32_bf16 v[16:19], v[124:127], v[116:119], v[16:19]
  ds_read_b128 v[156:159], v193 offset:12288
  v_mfma_f32_16x16x32_bf16 v[48:51], v[132:135], v[116:119], v[48:51]
  ds_read_b64_tr_b16 v[184:185], v194 offset:20480
  v_mfma_f32_16x16x32_bf16 v[52:55], v[136:139], v[116:119], v[52:55]
  ds_read_b64_tr_b16 v[186:187], v194 offset:20992
  v_mfma_f32_16x16x32_bf16 v[60:63], v[136:139], v[120:123], v[60:63]
  ds_read_b64_tr_b16 v[188:189], v195 offset:20480
  v_mfma_f32_16x16x32_bf16 v[56:59], v[132:135], v[120:123], v[56:59]
  ds_read_b64_tr_b16 v[190:191], v195 offset:20992
  v_mfma_f32_16x16x32_bf16 v[24:27], v[124:127], v[120:123], v[24:27]
  ds_read_b128 v[160:163], v193 offset:14336
  v_mfma_f32_16x16x32_bf16 v[28:31], v[128:131], v[120:123], v[28:31]
  ds_read_b128 v[164:167], v193 offset:16384
  v_mfma_f32_16x16x32_bf16 v[248:251], v[128:131], v[196:199], v[248:251]
  ds_read_b128 v[148:151], v193 offset:0
  v_mfma_f32_16x16x32_bf16 v[96:99], v[104:107], v[140:143], v[96:99]
  v_add_u32_e64 v192, s74, v192
  v_mfma_f32_16x16x32_bf16 v[100:103], v[104:107], v[144:147], v[100:103]
  v_add_u32_e64 v193, s74, v193
  v_mfma_f32_16x16x32_bf16 v[68:71], v[108:111], v[144:147], v[68:71]
  v_add_u32_e64 v194, s78, v194
  v_mfma_f32_16x16x32_bf16 v[64:67], v[108:111], v[140:143], v[64:67]
  v_add_u32_e64 v195, s78, v195
  v_mfma_f32_16x16x32_bf16 v[72:75], v[112:115], v[140:143], v[72:75]
  s_cmp_eq_u32 s70, s89
  s_cbranch_scc1 g1c11_hs
g1c11_hsb:
  v_mfma_f32_16x16x32_bf16 v[76:79], v[112:115], v[144:147], v[76:79]
  v_mfma_f32_16x16x32_bf16 v[84:87], v[116:119], v[144:147], v[84:87]
  s_sub_u32 s57, s70, 6
  v_mfma_f32_16x16x32_bf16 v[80:83], v[116:119], v[140:143], v[80:83]
  s_waitcnt lgkmcnt(0)
  s_cmp_lt_u32 s57, s88
  s_cbranch_scc1 g1c11_wm
g1c11_wmb:
  v_mfma_f32_16x16x32_bf16 v[88:91], v[120:123], v[140:143], v[88:91]
  v_mfma_f32_16x16x32_bf16 v[92:95], v[120:123], v[144:147], v[92:95]
  s_barrier
  v_mfma_f32_16x16x32_bf16 v[4:7], v[172:175], v[152:155], v[4:7]
  ds_read_b64_tr_b16 v[124:125], v194 offset:0
  v_mfma_f32_16x16x32_bf16 v[0:3], v[168:171], v[152:155], v[0:3]
  ds_read_b64_tr_b16 v[126:127], v194 offset:512
  v_mfma_f32_16x16x32_bf16 v[32:35], v[176:179], v[152:155], v[32:35]
  ds_read_b64_tr_b16 v[128:129], v195 offset:0
  v_mfma_f32_16x16x32_bf16 v[36:39], v[180:183], v[152:155], v[36:39]
  ds_read_b64_tr_b16 v[130:131], v195 offset:512
  v_mfma_f32_16x16x32_bf16 v[44:47], v[180:183], v[156:159], v[44:47]
  ds_read_b128 v[108:111], v192 offset:10240
  v_mfma_f32_16x16x32_bf16 v[40:43], v[176:179], v[156:159], v[40:43]
  ds_read_b64_tr_b16 v[132:133], v194 offset:8192
  v_mfma_f32_16x16x32_bf16 v[8:11], v[168:171], v[156:159], v[8:11]
  ds_read_b64_tr_b16 v[134:135], v194 offset:8704
  v_mfma_f32_16x16x32_bf16 v[12:15], v[172:175], v[156:159], v[12:15]
  ds_read_b64_tr_b16 v[136:137], v195 offset:8192
  v_mfma_f32_16x16x32_bf16 v[20:23], v[172:175], v[160:163], v[20:23]
  ds_read_b64_tr_b16 v[138:139], v195 offset:8704
  v_mfma_f32_16x16x32_bf16 v[16:19], v[168:171], v[160:163], v[16:19]
  ds_read_b128 v[112:115], v192 offset:12288
  v_mfma_f32_16x16x32_bf16 v[48:51], v[176:179], v[160:163], v[48:51]
  ds_read_b64_tr_b16 v[140:141], v194 offset:16384
  v_mfma_f32_16x16x32_bf16 v[52:55], v[180:183], v[160:163], v[52:55]
  ds_read_b64_tr_b16 v[142:143], v194 offset:16896
  v_mfma_f32_16x16x32_bf16 v[60:63], v[180:183], v[164:167], v[60:63]
  ds_read_b64_tr_b16 v[144:145], v195 offset:16384
  v_mfma_f32_16x16x32_bf16 v[56:59], v[176:179], v[164:167], v[56:59]
  ds_read_b64_tr_b16 v[146:147], v195 offset:16896
  v_mfma_f32_16x16x32_bf16 v[24:27], v[168:171], v[164:167], v[24:27]
  ds_read_b128 v[116:119], v192 offset:14336
  v_mfma_f32_16x16x32_bf16 v[28:31], v[172:175], v[164:167], v[28:31]
  ds_read_b128 v[120:123], v192 offset:16384
  v_mfma_f32_16x16x32_bf16 v[248:251], v[172:175], v[196:199], v[248:251]
  ds_read_b128 v[104:107], v192 offset:0
  s_cmp_eq_u32 s71, 2
  v_mfma_f32_16x16x32_bf16 v[96:99], v[148:151], v[184:187], v[96:99]
  s_cselect_b32 s74, s72, s73
  v_mfma_f32_16x16x32_bf16 v[100:103], v[148:151], v[188:191], v[100:103]
  s_cselect_b32 s71, -1, s71
  v_mfma_f32_16x16x32_bf16 v[68:71], v[152:155], v[188:191], v[68:71]
  s_add_u32 s71, s71, 1
  v_mfma_f32_16x16x32_bf16 v[64:67], v[152:155], v[184:187], v[64:67]
  s_cmp_eq_u32 s75, 3
  v_mfma_f32_16x16x32_bf16 v[72:75], v[156:159], v[184:187], v[72:75]
  s_cselect_b32 s78, s76, s77
  v_mfma_f32_16x16x32_bf16 v[76:79], v[156:159], v[188:191], v[76:79]
  s_cselect_b32 s75, -1, s75
  v_mfma_f32_16x16x32_bf16 v[84:87], v[160:163], v[188:191], v[84:87]
  s_add_u32 s75, s75, 1
  v_mfma_f32_16x16x32_bf16 v[80:83], v[160:163], v[184:187], v[80:83]
  s_waitcnt lgkmcnt(0)
  s_add_u32 s70, s70, 1
  v_mfma_f32_16x16x32_bf16 v[88:91], v[164:167], v[184:187], v[88:91]
  s_cmp_lt_u32 s70, 15
  v_mfma_f32_16x16x32_bf16 v[92:95], v[164:167], v[188:191], v[92:95]
  s_cbranch_scc1 g1c11_loop
  v_mfma_f32_16x16x32_bf16 v[4:7], v[128:131], v[108:111], v[4:7]
  ds_read_b64_tr_b16 v[168:169], v194 offset:4096
  v_mfma_f32_16x16x32_bf16 v[0:3], v[124:127], v[108:111], v[0:3]
  ds_read_b64_tr_b16 v[170:171], v194 offset:4608
  v_mfma_f32_16x16x32_bf16 v[32:35], v[132:135], v[108:111], v[32:35]
  ds_read_b64_tr_b16 v[172:173], v195 offset:4096
  v_mfma_f32_16x16x32_bf16 v[36:39], v[136:139], v[108:111], v[36:39]
  ds_read_b64_tr_b16 v[174:175], v195 offset:4608
  v_mfma_f32_16x16x32_bf16 v[44:47], v[136:139], v[112:115], v[44:47]
  ds_read_b128 v[152:155], v193 offset:10240
  v_mfma_f32_16x16x32_bf16 v[40:43], v[132:135], v[112:115], v[40:43]
  ds_read_b64_tr_b16 v[176:177], v194 offset:12288
  v_mfma_f32_16x16x32_bf16 v[8:11], v[124:127], v[112:115], v[8:11]
  ds_read_b64_tr_b16 v[178:179], v194 offset:12800
  v_mfma_f32_16x16x32_bf16 v[12:15], v[128:131], v[112:115], v[12:15]
  ds_read_b64_tr_b16 v[180:181], v195 offset:12288
  v_mfma_f32_16x16x32_bf16 v[20:23], v[128:131], v[116:119], v[20:23]
  ds_read_b64_tr_b16 v[182:183], v195 offset:12800
  v_mfma_f32_16x16x32_bf16 v[16:19], v[124:127], v[116:119], v[16:19]
  ds_read_b128 v[156:159], v193 offset:12288
  v_and_b32 v246, 15, v247
  v_mfma_f32_16x16x32_bf16 v[48:51], v[132:135], v[116:119], v[48:51]
  ds_read_b64_tr_b16 v[184:185], v194 offset:20480
  v_lshrrev_b32_e64 v245, 4, v247
  v_mfma_f32_16x16x32_bf16 v[52:55], v[136:139], v[116:119], v[52:55]
  ds_read_b64_tr_b16 v[186:187], v194 offset:20992
  v_lshlrev_b32_e64 v244, 2, v246
  v_mfma_f32_16x16x32_bf16 v[60:63], v[136:139], v[120:123], v[60:63]
  ds_read_b64_tr_b16 v[188:189], v195 offset:20480
  v_lshlrev_b32_e64 v243, 4, v245
  v_mfma_f32_16x16x32_bf16 v[56:59], v[132:135], v[120:123], v[56:59]
  ds_read_b64_tr_b16 v[190:191], v195 offset:20992
  s_lshl_b32 s57, s56, 7
  v_mfma_f32_16x16x32_bf16 v[24:27], v[124:127], v[120:123], v[24:27]
  ds_read_b128 v[160:163], v193 offset:14336
  s_and_b32 s58, s50, 1
  v_mfma_f32_16x16x32_bf16 v[28:31], v[128:131], v[120:123], v[28:31]
  ds_read_b128 v[164:167], v193 offset:16384
  s_mul_i32 s58, s58, 768
  v_mfma_f32_16x16x32_bf16 v[248:251], v[128:131], v[104:107], v[248:251]
  ds_read_b128 v[148:151], v193 offset:0
  s_add_u32 s57, s57, s58
  v_mfma_f32_16x16x32_bf16 v[96:99], v[104:107], v[140:143], v[96:99]
  s_add_u32 s57, s57, 154752
  v_add_u32 v242, s57, v243
  v_mfma_f32_16x16x32_bf16 v[100:103], v[104:107], v[144:147], v[100:103]
  v_add_u32_e64 v241, s57, v244
  v_add_u32 v244, 153600, v244
  v_mfma_f32_16x16x32_bf16 v[68:71], v[108:111], v[144:147], v[68:71]
  v_add_u32 v243, 153600, v243
  s_lshl_b32 s57, s56, 12
  v_mfma_f32_16x16x32_bf16 v[64:67], v[108:111], v[140:143], v[64:67]
  v_lshlrev_b32 v240, 4, v247
  v_add_u32_e64 v240, s57, v240
  v_mfma_f32_16x16x32_bf16 v[72:75], v[112:115], v[140:143], v[72:75]
  v_lshlrev_b32 v239, 3, v247
  v_add_u32 v239, s57, v239
  v_mfma_f32_16x16x32_bf16 v[76:79], v[112:115], v[144:147], v[76:79]
  v_lshlrev_b32 v238, 4, v247
  s_lshl_b32 s57, s51, 4
  v_mfma_f32_16x16x32_bf16 v[84:87], v[116:119], v[144:147], v[84:87]
  s_add_u32 s57, s57, s52
  s_lshl_b32 s57, s57, 14
  v_mfma_f32_16x16x32_bf16 v[80:83], v[116:119], v[140:143], v[80:83]
  s_lshl_b32 s58, s56, 10
  s_add_u32 s57, s57, s58
  v_mfma_f32_16x16x32_bf16 v[88:91], v[120:123], v[140:143], v[88:91]
  s_add_u32 s57, s57, 8192
  v_add_u32_e64 v238, s57, v238
  v_mfma_f32_16x16x32_bf16 v[92:95], v[120:123], v[144:147], v[92:95]
  s_mov_b32 s75, 1048744942
  s_movk_i32 s76, 4096
  s_waitcnt lgkmcnt(0)
  s_barrier
g1c11_last:
  v_mfma_f32_16x16x32_bf16 v[4:7], v[172:175], v[152:155], v[4:7]
  ds_read_b128 v[196:199], v243 offset:0
  v_mfma_f32_16x16x32_bf16 v[0:3], v[168:171], v[152:155], v[0:3]
  ds_read_b128 v[216:219], v243 offset:576
  v_mfma_f32_16x16x32_bf16 v[32:35], v[176:179], v[152:155], v[32:35]
  ds_read_b32 v105, v244 offset:320
  v_mfma_f32_16x16x32_bf16 v[36:39], v[180:183], v[152:155], v[36:39]
  ds_read_b32 v110, v244 offset:896
  v_mfma_f32_16x16x32_bf16 v[44:47], v[180:183], v[156:159], v[44:47]
  ds_read_b128 v[200:203], v243 offset:320
  v_mfma_f32_16x16x32_bf16 v[40:43], v[176:179], v[156:159], v[40:43]
  ds_read_b128 v[220:223], v243 offset:896
  v_mfma_f32_16x16x32_bf16 v[8:11], v[168:171], v[156:159], v[8:11]
  ds_read_b32 v106, v244 offset:384
  v_mfma_f32_16x16x32_bf16 v[12:15], v[172:175], v[156:159], v[12:15]
  ds_read_b32 v111, v244 offset:960
  v_mfma_f32_16x16x32_bf16 v[20:23], v[172:175], v[160:163], v[20:23]
  ds_read_b128 v[204:207], v243 offset:384
  v_mfma_f32_16x16x32_bf16 v[16:19], v[168:171], v[160:163], v[16:19]
  ds_read_b128 v[224:227], v243 offset:960
  v_mfma_f32_16x16x32_bf16 v[48:51], v[176:179], v[160:163], v[48:51]
  ds_read_b32 v107, v244 offset:448
  v_mfma_f32_16x16x32_bf16 v[52:55], v[180:183], v[160:163], v[52:55]
  ds_read_b32 v112, v244 offset:1024
  v_mfma_f32_16x16x32_bf16 v[60:63], v[180:183], v[164:167], v[60:63]
  ds_read_b128 v[208:211], v243 offset:448
  v_mfma_f32_16x16x32_bf16 v[56:59], v[176:179], v[164:167], v[56:59]
  ds_read_b128 v[228:231], v243 offset:1024
  v_mfma_f32_16x16x32_bf16 v[24:27], v[168:171], v[164:167], v[24:27]
  ds_read_b32 v108, v244 offset:512
  v_mfma_f32_16x16x32_bf16 v[28:31], v[172:175], v[164:167], v[28:31]
  ds_read_b32 v113, v244 offset:1088
  v_mfma_f32_16x16x32_bf16 v[248:251], v[172:175], v[148:151], v[248:251]
  ds_read_b128 v[212:215], v243 offset:512
  v_mfma_f32_16x16x32_bf16 v[96:99], v[148:151], v[184:187], v[96:99]
  ds_read_b128 v[232:235], v243 offset:1088
  v_mfma_f32_16x16x32_bf16 v[100:103], v[148:151], v[188:191], v[100:103]
  v_and_b32 v236, 1, v246
  v_lshlrev_b32_e64 v236, 4, v236
  v_mfma_f32_16x16x32_bf16 v[68:71], v[152:155], v[188:191], v[68:71]
  s_mov_b32 s57, 0x0c0c0100
  v_alignbit_b32 v192, s57, s57, v236
  v_mfma_f32_16x16x32_bf16 v[64:67], v[152:155], v[184:187], v[64:67]
  s_mov_b32 s58, 0x0c0c0302
  v_mfma_f32_16x16x32_bf16 v[72:75], v[156:159], v[184:187], v[72:75]
  v_alignbit_b32 v193, s58, s58, v236
  v_mfma_f32_16x16x32_bf16 v[76:79], v[156:159], v[188:191], v[76:79]
  v_mov_b32 v236, 0x0c0c0c0c
  v_mfma_f32_16x16x32_bf16 v[84:87], v[160:163], v[188:191], v[84:87]
  v_cndmask_b32 v194, v236, v192, s[96:97]
  v_mfma_f32_16x16x32_bf16 v[80:83], v[160:163], v[184:187], v[80:83]
  v_cndmask_b32 v195, v236, v193, s[98:99]
  v_mfma_f32_16x16x32_bf16 v[88:91], v[164:167], v[184:187], v[88:91]
  v_cndmask_b32 v192, v192, v236, s[96:97]
  v_mfma_f32_16x16x32_bf16 v[92:95], v[164:167], v[188:191], v[92:95]
  v_cndmask_b32 v193, v193, v236, s[98:99]
  s_mov_b32 exec_lo, 0x10001
  s_mov_b32 exec_hi, 0x10001
  ds_write_b128 v242, v[248:251] offset:64
  s_mov_b32 exec_lo, 0xffff
  s_mov_b32 exec_hi, 0
  ds_write_b32 v241, v96 offset:512
  ds_write_b32 v241, v100 offset:576
  s_mov_b64 exec, -1
  v_mov_b32 v248, 0x3f803f80
  v_mov_b32 v249, 0x3f803f80
  v_mov_b32 v250, 0x3f803f80
  v_mov_b32 v251, 0x3f803f80
  s_waitcnt lgkmcnt(0)
  s_barrier
  ds_read_b128 v[114:117], v242 offset:0
  ds_read_b128 v[122:125], v242 offset:256
  ds_read_b32 v130, v241 offset:512
  ds_read_b128 v[118:121], v242 offset:64
  ds_read_b128 v[126:129], v242 offset:320
  ds_read_b32 v131, v241 offset:576
  s_waitcnt lgkmcnt(0)
  s_branch g1e1
g1c11_hs:
  v_mov_b32 v236, 156304
  ds_read_b32 v237, v236
  s_waitcnt vmcnt(0) lgkmcnt(0)
  v_readfirstlane_b32 s93, v237
  v_mov_b32 v236, 156296
  v_mov_b32 v237, 1
  s_mov_b64 exec, 1
  ds_add_rtn_u32 v238, v236, v237
  s_waitcnt lgkmcnt(0)
  v_readfirstlane_b32 s57, v238
  s_nop 3
  s_and_b32 s57, s57, 3
  s_cmp_eq_u32 s57, 3
  s_cbranch_scc0 sig_hs1_skip
  s_lshr_b32 s57, s2, 4
  s_add_u32 s57, s57, 128
  s_mul_i32 s57, s57, 16384
  s_and_b32 s58, s2, 15
  s_mul_i32 s58, s58, 1024
  s_add_u32 s57, s57, s58
  v_mov_b32 v236, 0
  v_mov_b32_e64 v237, s93
  buffer_store_dword v237, v236, s[32:35], s57 offen sc1
sig_hs1_skip:
  s_mov_b64 exec, -1
  s_mov_b32 s89, -1
  s_branch g1c11_hsb
g1c11_wm:
  s_lshl_b32 s58, s2, 2
  s_add_u32 s58, s58, s55
  v_lshlrev_b32 v239, 7, v247
  s_mov_b32 exec_hi, 0
  s_cmp_lg_u32 s57, 0
  s_cbranch_scc1 g1c11_wm1
  s_lshl_b32 s58, s58, 11
  s_mov_b32 exec_lo, 0xffff
  buffer_load_dword v253, v239, s[20:23], s58 offen
  s_branch g1c11_wm2
g1c11_wm1:
  s_mul_i32 s58, s58, 6144
  s_mul_i32 s57, s57, 3072
  s_add_u32 s58, s58, s57
  s_sub_u32 s58, s58, 3072
  s_mov_b32 s60, s44
  s_mov_b32 s61, s45
  s_mov_b32 s62, 6291456
  s_mov_b32 s63, 0x20000
  s_mov_b32 exec_lo, 0xffffff
  buffer_load_dword v253, v239, s[60:63], s58 offen
g1c11_wm2:
  s_mov_b64 exec, -1
  s_branch g1c11_wmb
g1c10:
  s_barrier
  ds_read_b64_tr_b16 v[124:125], v194 offset:0
  ds_read_b64_tr_b16 v[126:127], v194 offset:512
  ds_read_b64_tr_b16 v[128:129], v195 offset:0
  ds_read_b64_tr_b16 v[130:131], v195 offset:512
  ds_read_b128 v[108:111], v192 offset:10240
  ds_read_b64_tr_b16 v[132:133], v194 offset:8192
  ds_read_b64_tr_b16 v[134:135], v194 offset:8704
  ds_read_b64_tr_b16 v[136:137], v195 offset:8192
  ds_read_b64_tr_b16 v[138:139], v195 offset:8704
  ds_read_b128 v[112:115], v192 offset:12288
  ds_read_b64_tr_b16 v[140:141], v194 offset:16384
  ds_read_b64_tr_b16 v[142:143], v194 offset:16896
  ds_read_b64_tr_b16 v[144:145], v195 offset:16384
  ds_read_b64_tr_b16 v[146:147], v195 offset:16896
  ds_read_b128 v[116:119], v192 offset:14336
  ds_read_b128 v[120:123], v192 offset:16384
  ds_read_b128 v[104:107], v192 offset:0
  s_mov_b32 s70, 0
  s_mov_b32 s71, 0
  s_mov_b32 s72, 4294930432
  s_mov_b32 s73, 18432
  s_mov_b32 s75, 0
  s_mov_b32 s76, 4294893568
  s_mov_b32 s77, 24576
  s_cmp_eq_u32 s71, 2
  s_cselect_b32 s74, s72, s73
  s_cselect_b32 s71, -1, s71
  s_add_u32 s71, s71, 1
  s_cmp_eq_u32 s75, 3
  s_cselect_b32 s78, s76, s77
  s_cselect_b32 s75, -1, s75
  s_add_u32 s75, s75, 1
  s_waitcnt lgkmcnt(0)
g1c10_loop:
  v_mfma_f32_16x16x32_bf16 v[36:39], v[136:139], v[108:111], v[36:39]
  ds_read_b64_tr_b16 v[168:169], v194 offset:4096
  v_mfma_f32_16x16x32_bf16 v[32:35], v[132:135], v[108:111], v[32:35]
  ds_read_b64_tr_b16 v[170:171], v194 offset:4608
  v_mfma_f32_16x16x32_bf16 v[0:3], v[124:127], v[108:111], v[0:3]
  ds_read_b64_tr_b16 v[172:173], v195 offset:4096
  v_mfma_f32_16x16x32_bf16 v[4:7], v[128:131], v[108:111], v[4:7]
  ds_read_b64_tr_b16 v[174:175], v195 offset:4608
  v_mfma_f32_16x16x32_bf16 v[12:15], v[128:131], v[112:115], v[12:15]
  ds_read_b128 v[152:155], v193 offset:10240
  v_mfma_f32_16x16x32_bf16 v[8:11], v[124:127], v[112:115], v[8:11]
  ds_read_b64_tr_b16 v[176:177], v194 offset:12288
  v_mfma_f32_16x16x32_bf16 v[40:43], v[132:135], v[112:115], v[40:43]
  ds_read_b64_tr_b16 v[178:179], v194 offset:12800
  v_mfma_f32_16x16x32_bf16 v[44:47], v[136:139], v[112:115], v[44:47]
  ds_read_b64_tr_b16 v[180:181], v195 offset:12288
  v_mfma_f32_16x16x32_bf16 v[52:55], v[136:139], v[116:119], v[52:55]
  ds_read_b64_tr_b16 v[182:183], v195 offset:12800
  v_mfma_f32_16x16x32_bf16 v[48:51], v[132:135], v[116:119], v[48:51]
  ds_read_b128 v[156:159], v193 offset:12288
  v_mfma_f32_16x16x32_bf16 v[16:19], v[124:127], v[116:119], v[16:19]
  ds_read_b64_tr_b16 v[184:185], v194 offset:20480
  v_mfma_f32_16x16x32_bf16 v[20:23], v[128:131], v[116:119], v[20:23]
  ds_read_b64_tr_b16 v[186:187], v194 offset:20992
  v_mfma_f32_16x16x32_bf16 v[28:31], v[128:131], v[120:123], v[28:31]
  ds_read_b64_tr_b16 v[188:189], v195 offset:20480
  v_mfma_f32_16x16x32_bf16 v[24:27], v[124:127], v[120:123], v[24:27]
  ds_read_b64_tr_b16 v[190:191], v195 offset:20992
  v_mfma_f32_16x16x32_bf16 v[56:59], v[132:135], v[120:123], v[56:59]
  ds_read_b128 v[160:163], v193 offset:14336
  v_mfma_f32_16x16x32_bf16 v[60:63], v[136:139], v[120:123], v[60:63]
  ds_read_b128 v[164:167], v193 offset:16384
  v_mfma_f32_16x16x32_bf16 v[96:99], v[104:107], v[140:143], v[96:99]
  ds_read_b128 v[148:151], v193 offset:0
  v_mfma_f32_16x16x32_bf16 v[100:103], v[104:107], v[144:147], v[100:103]
  v_add_u32 v192, s74, v192
  v_mfma_f32_16x16x32_bf16 v[68:71], v[108:111], v[144:147], v[68:71]
  v_add_u32_e64 v193, s74, v193
  v_mfma_f32_16x16x32_bf16 v[64:67], v[108:111], v[140:143], v[64:67]
  v_add_u32_e64 v194, s78, v194
  v_mfma_f32_16x16x32_bf16 v[72:75], v[112:115], v[140:143], v[72:75]
  v_add_u32_e64 v195, s78, v195
  v_mfma_f32_16x16x32_bf16 v[76:79], v[112:115], v[144:147], v[76:79]
  v_mfma_f32_16x16x32_bf16 v[84:87], v[116:119], v[144:147], v[84:87]
  v_mfma_f32_16x16x32_bf16 v[80:83], v[116:119], v[140:143], v[80:83]
  s_waitcnt lgkmcnt(0)
  v_mfma_f32_16x16x32_bf16 v[88:91], v[120:123], v[140:143], v[88:91]
  v_mfma_f32_16x16x32_bf16 v[92:95], v[120:123], v[144:147], v[92:95]
  s_barrier
  v_mfma_f32_16x16x32_bf16 v[36:39], v[180:183], v[152:155], v[36:39]
  ds_read_b64_tr_b16 v[124:125], v194 offset:0
  v_mfma_f32_16x16x32_bf16 v[32:35], v[176:179], v[152:155], v[32:35]
  ds_read_b64_tr_b16 v[126:127], v194 offset:512
  v_mfma_f32_16x16x32_bf16 v[0:3], v[168:171], v[152:155], v[0:3]
  ds_read_b64_tr_b16 v[128:129], v195 offset:0
  v_mfma_f32_16x16x32_bf16 v[4:7], v[172:175], v[152:155], v[4:7]
  ds_read_b64_tr_b16 v[130:131], v195 offset:512
  v_mfma_f32_16x16x32_bf16 v[12:15], v[172:175], v[156:159], v[12:15]
  ds_read_b128 v[108:111], v192 offset:10240
  v_mfma_f32_16x16x32_bf16 v[8:11], v[168:171], v[156:159], v[8:11]
  ds_read_b64_tr_b16 v[132:133], v194 offset:8192
  v_mfma_f32_16x16x32_bf16 v[40:43], v[176:179], v[156:159], v[40:43]
  ds_read_b64_tr_b16 v[134:135], v194 offset:8704
  v_mfma_f32_16x16x32_bf16 v[44:47], v[180:183], v[156:159], v[44:47]
  ds_read_b64_tr_b16 v[136:137], v195 offset:8192
  v_mfma_f32_16x16x32_bf16 v[52:55], v[180:183], v[160:163], v[52:55]
  ds_read_b64_tr_b16 v[138:139], v195 offset:8704
  v_mfma_f32_16x16x32_bf16 v[48:51], v[176:179], v[160:163], v[48:51]
  ds_read_b128 v[112:115], v192 offset:12288
  v_mfma_f32_16x16x32_bf16 v[16:19], v[168:171], v[160:163], v[16:19]
  ds_read_b64_tr_b16 v[140:141], v194 offset:16384
  v_mfma_f32_16x16x32_bf16 v[20:23], v[172:175], v[160:163], v[20:23]
  ds_read_b64_tr_b16 v[142:143], v194 offset:16896
  v_mfma_f32_16x16x32_bf16 v[28:31], v[172:175], v[164:167], v[28:31]
  ds_read_b64_tr_b16 v[144:145], v195 offset:16384
  v_mfma_f32_16x16x32_bf16 v[24:27], v[168:171], v[164:167], v[24:27]
  ds_read_b64_tr_b16 v[146:147], v195 offset:16896
  v_mfma_f32_16x16x32_bf16 v[56:59], v[176:179], v[164:167], v[56:59]
  ds_read_b128 v[116:119], v192 offset:14336
  v_mfma_f32_16x16x32_bf16 v[60:63], v[180:183], v[164:167], v[60:63]
  ds_read_b128 v[120:123], v192 offset:16384
  s_cmp_eq_u32 s71, 2
  v_mfma_f32_16x16x32_bf16 v[96:99], v[148:151], v[184:187], v[96:99]
  ds_read_b128 v[104:107], v192 offset:0
  s_cselect_b32 s74, s72, s73
  v_mfma_f32_16x16x32_bf16 v[100:103], v[148:151], v[188:191], v[100:103]
  s_cselect_b32 s71, -1, s71
  v_mfma_f32_16x16x32_bf16 v[68:71], v[152:155], v[188:191], v[68:71]
  s_add_u32 s71, s71, 1
  v_mfma_f32_16x16x32_bf16 v[64:67], v[152:155], v[184:187], v[64:67]
  s_cmp_eq_u32 s75, 3
  v_mfma_f32_16x16x32_bf16 v[72:75], v[156:159], v[184:187], v[72:75]
  s_cselect_b32 s78, s76, s77
  v_mfma_f32_16x16x32_bf16 v[76:79], v[156:159], v[188:191], v[76:79]
  s_cselect_b32 s75, -1, s75
  v_mfma_f32_16x16x32_bf16 v[84:87], v[160:163], v[188:191], v[84:87]
  s_add_u32 s75, s75, 1
  v_mfma_f32_16x16x32_bf16 v[80:83], v[160:163], v[184:187], v[80:83]
  s_waitcnt lgkmcnt(0)
  s_add_u32 s70, s70, 1
  v_mfma_f32_16x16x32_bf16 v[88:91], v[164:167], v[184:187], v[88:91]
  s_cmp_lt_u32 s70, 15
  v_mfma_f32_16x16x32_bf16 v[92:95], v[164:167], v[188:191], v[92:95]
  s_cbranch_scc1 g1c10_loop
  v_mfma_f32_16x16x32_bf16 v[36:39], v[136:139], v[108:111], v[36:39]
  ds_read_b64_tr_b16 v[168:169], v194 offset:4096
  v_mfma_f32_16x16x32_bf16 v[32:35], v[132:135], v[108:111], v[32:35]
  ds_read_b64_tr_b16 v[170:171], v194 offset:4608
  v_mfma_f32_16x16x32_bf16 v[0:3], v[124:127], v[108:111], v[0:3]
  ds_read_b64_tr_b16 v[172:173], v195 offset:4096
  v_mfma_f32_16x16x32_bf16 v[4:7], v[128:131], v[108:111], v[4:7]
  ds_read_b64_tr_b16 v[174:175], v195 offset:4608
  v_mfma_f32_16x16x32_bf16 v[12:15], v[128:131], v[112:115], v[12:15]
  ds_read_b128 v[152:155], v193 offset:10240
  v_mfma_f32_16x16x32_bf16 v[8:11], v[124:127], v[112:115], v[8:11]
  ds_read_b64_tr_b16 v[176:177], v194 offset:12288
  v_mfma_f32_16x16x32_bf16 v[40:43], v[132:135], v[112:115], v[40:43]
  ds_read_b64_tr_b16 v[178:179], v194 offset:12800
  v_mfma_f32_16x16x32_bf16 v[44:47], v[136:139], v[112:115], v[44:47]
  ds_read_b64_tr_b16 v[180:181], v195 offset:12288
  v_and_b32_e64 v246, 15, v247
  v_mfma_f32_16x16x32_bf16 v[52:55], v[136:139], v[116:119], v[52:55]
  ds_read_b64_tr_b16 v[182:183], v195 offset:12800
  v_lshrrev_b32_e64 v245, 4, v247
  v_mfma_f32_16x16x32_bf16 v[48:51], v[132:135], v[116:119], v[48:51]
  ds_read_b128 v[156:159], v193 offset:12288
  v_lshlrev_b32_e64 v244, 2, v246
  v_mfma_f32_16x16x32_bf16 v[16:19], v[124:127], v[116:119], v[16:19]
  ds_read_b64_tr_b16 v[184:185], v194 offset:20480
  v_lshlrev_b32_e64 v243, 4, v245
  v_mfma_f32_16x16x32_bf16 v[20:23], v[128:131], v[116:119], v[20:23]
  ds_read_b64_tr_b16 v[186:187], v194 offset:20992
  s_lshl_b32 s57, s56, 7
  v_mfma_f32_16x16x32_bf16 v[28:31], v[128:131], v[120:123], v[28:31]
  ds_read_b64_tr_b16 v[188:189], v195 offset:20480
  s_and_b32 s58, s50, 1
  v_mfma_f32_16x16x32_bf16 v[24:27], v[124:127], v[120:123], v[24:27]
  ds_read_b64_tr_b16 v[190:191], v195 offset:20992
  s_mul_i32 s58, s58, 768
  v_mfma_f32_16x16x32_bf16 v[56:59], v[132:135], v[120:123], v[56:59]
  ds_read_b128 v[160:163], v193 offset:14336
  s_add_u32 s57, s57, s58
  v_mfma_f32_16x16x32_bf16 v[60:63], v[136:139], v[120:123], v[60:63]
  ds_read_b128 v[164:167], v193 offset:16384
  s_add_u32 s57, s57, 154752
  v_mfma_f32_16x16x32_bf16 v[96:99], v[104:107], v[140:143], v[96:99]
  ds_read_b128 v[148:151], v193 offset:0
  v_add_u32 v242, s57, v243
  v_mfma_f32_16x16x32_bf16 v[100:103], v[104:107], v[144:147], v[100:103]
  v_add_u32_e64 v241, s57, v244
  v_add_u32 v244, 153600, v244
  v_mfma_f32_16x16x32_bf16 v[68:71], v[108:111], v[144:147], v[68:71]
  v_add_u32 v243, 153600, v243
  s_lshl_b32 s57, s56, 12
  v_mfma_f32_16x16x32_bf16 v[64:67], v[108:111], v[140:143], v[64:67]
  v_lshlrev_b32 v240, 4, v247
  v_add_u32_e64 v240, s57, v240
  v_mfma_f32_16x16x32_bf16 v[72:75], v[112:115], v[140:143], v[72:75]
  v_lshlrev_b32 v239, 3, v247
  v_add_u32 v239, s57, v239
  v_mfma_f32_16x16x32_bf16 v[76:79], v[112:115], v[144:147], v[76:79]
  v_lshlrev_b32 v238, 4, v247
  s_lshl_b32 s57, s51, 4
  v_mfma_f32_16x16x32_bf16 v[84:87], v[116:119], v[144:147], v[84:87]
  s_add_u32 s57, s57, s52
  s_lshl_b32 s57, s57, 14
  v_mfma_f32_16x16x32_bf16 v[80:83], v[116:119], v[140:143], v[80:83]
  s_lshl_b32 s58, s56, 10
  s_add_u32 s57, s57, s58
  v_mfma_f32_16x16x32_bf16 v[88:91], v[120:123], v[140:143], v[88:91]
  s_add_u32 s57, s57, 8192
  v_add_u32_e64 v238, s57, v238
  v_mfma_f32_16x16x32_bf16 v[92:95], v[120:123], v[144:147], v[92:95]
  s_mov_b32 s75, 1048744942
  s_movk_i32 s76, 4096
  s_waitcnt lgkmcnt(0)
  s_barrier
g1c10_last:
  v_mfma_f32_16x16x32_bf16 v[36:39], v[180:183], v[152:155], v[36:39]
  ds_read_b128 v[196:199], v243 offset:0
  v_mfma_f32_16x16x32_bf16 v[32:35], v[176:179], v[152:155], v[32:35]
  ds_read_b128 v[216:219], v243 offset:576
  v_mfma_f32_16x16x32_bf16 v[0:3], v[168:171], v[152:155], v[0:3]
  ds_read_b32 v105, v244 offset:320
  v_mfma_f32_16x16x32_bf16 v[4:7], v[172:175], v[152:155], v[4:7]
  ds_read_b32 v110, v244 offset:896
  v_mfma_f32_16x16x32_bf16 v[12:15], v[172:175], v[156:159], v[12:15]
  ds_read_b128 v[200:203], v243 offset:320
  v_mfma_f32_16x16x32_bf16 v[8:11], v[168:171], v[156:159], v[8:11]
  ds_read_b128 v[220:223], v243 offset:896
  v_mfma_f32_16x16x32_bf16 v[40:43], v[176:179], v[156:159], v[40:43]
  ds_read_b32 v106, v244 offset:384
  v_mfma_f32_16x16x32_bf16 v[44:47], v[180:183], v[156:159], v[44:47]
  ds_read_b32 v111, v244 offset:960
  v_mfma_f32_16x16x32_bf16 v[52:55], v[180:183], v[160:163], v[52:55]
  ds_read_b128 v[204:207], v243 offset:384
  v_mfma_f32_16x16x32_bf16 v[48:51], v[176:179], v[160:163], v[48:51]
  ds_read_b128 v[224:227], v243 offset:960
  v_mfma_f32_16x16x32_bf16 v[16:19], v[168:171], v[160:163], v[16:19]
  ds_read_b32 v107, v244 offset:448
  v_mfma_f32_16x16x32_bf16 v[20:23], v[172:175], v[160:163], v[20:23]
  ds_read_b32 v112, v244 offset:1024
  v_mfma_f32_16x16x32_bf16 v[28:31], v[172:175], v[164:167], v[28:31]
  ds_read_b128 v[208:211], v243 offset:448
  v_mfma_f32_16x16x32_bf16 v[24:27], v[168:171], v[164:167], v[24:27]
  ds_read_b128 v[228:231], v243 offset:1024
  v_and_b32 v236, 1, v246
  v_mfma_f32_16x16x32_bf16 v[56:59], v[176:179], v[164:167], v[56:59]
  ds_read_b32 v108, v244 offset:512
  v_lshlrev_b32_e64 v236, 4, v236
  v_mfma_f32_16x16x32_bf16 v[60:63], v[180:183], v[164:167], v[60:63]
  ds_read_b32 v113, v244 offset:1088
  s_mov_b32 s57, 0x0c0c0100
  v_mfma_f32_16x16x32_bf16 v[96:99], v[148:151], v[184:187], v[96:99]
  ds_read_b128 v[212:215], v243 offset:512
  v_alignbit_b32 v192, s57, s57, v236
  v_mfma_f32_16x16x32_bf16 v[100:103], v[148:151], v[188:191], v[100:103]
  ds_read_b128 v[232:235], v243 offset:1088
  s_mov_b32 s58, 0x0c0c0302
  v_mfma_f32_16x16x32_bf16 v[68:71], v[152:155], v[188:191], v[68:71]
  ds_read_b128 v[114:117], v242 offset:0
  v_alignbit_b32 v193, s58, s58, v236
  v_mfma_f32_16x16x32_bf16 v[64:67], v[152:155], v[184:187], v[64:67]
  ds_read_b128 v[122:125], v242 offset:256
  v_mov_b32 v236, 0x0c0c0c0c
  v_mfma_f32_16x16x32_bf16 v[72:75], v[156:159], v[184:187], v[72:75]
  ds_read_b32 v130, v241 offset:512
  v_cndmask_b32 v194, v236, v192, s[96:97]
  v_mfma_f32_16x16x32_bf16 v[76:79], v[156:159], v[188:191], v[76:79]
  ds_read_b128 v[118:121], v242 offset:64
  v_cndmask_b32 v195, v236, v193, s[98:99]
  v_mfma_f32_16x16x32_bf16 v[84:87], v[160:163], v[188:191], v[84:87]
  ds_read_b128 v[126:129], v242 offset:320
  v_cndmask_b32 v192, v192, v236, s[96:97]
  v_mfma_f32_16x16x32_bf16 v[80:83], v[160:163], v[184:187], v[80:83]
  ds_read_b32 v131, v241 offset:576
  v_cndmask_b32 v193, v193, v236, s[98:99]
  v_mfma_f32_16x16x32_bf16 v[88:91], v[164:167], v[184:187], v[88:91]
  v_mov_b32 v248, 0x3f803f80
  v_mov_b32 v249, 0x3f803f80
  v_mfma_f32_16x16x32_bf16 v[92:95], v[164:167], v[188:191], v[92:95]
  v_mov_b32 v250, 0x3f803f80
  v_mov_b32 v251, 0x3f803f80
  s_waitcnt lgkmcnt(0)
g1e1:
  s_nop 0
  v_pk_fma_f32 v[96:97], v[196:197], v[130:131], v[96:97] op_sel:[0,0,0] op_sel_hi:[1,0,1]
  v_pk_mul_f32 v[96:97], v[96:97], v[216:217]
  v_pk_fma_f32 v[98:99], v[198:199], v[130:131], v[98:99] op_sel:[0,0,0] op_sel_hi:[1,0,1]
  v_pk_mul_f32 v[98:99], v[98:99], v[218:219]
  v_pk_fma_f32 v[100:101], v[196:197], v[130:131], v[100:101] op_sel:[0,1,0] op_sel_hi:[1,1,1]
  v_pk_mul_f32 v[100:101], v[100:101], v[216:217]
  v_pk_fma_f32 v[102:103], v[198:199], v[130:131], v[102:103] op_sel:[0,1,0] op_sel_hi:[1,1,1]
  v_pk_mul_f32 v[102:103], v[102:103], v[218:219]
  v_cvt_pk_bf16_f32 v168, v96, v97
  v_cvt_pk_bf16_f32 v169, v98, v99
  v_cvt_pk_bf16_f32 v178, v100, v101
  v_cvt_pk_bf16_f32 v179, v102, v103
  ds_write_b64 v239, v[168:169] offset:2048
  ds_write_b64 v239, v[178:179] offset:2560
  v_pk_fma_f32 v[32:33], v[122:123], v[104:105], v[32:33] op_sel:[0,1,0] op_sel_hi:[1,1,1]
  v_pk_mul_f32 v[32:33], v[32:33], v[110:111] op_sel:[0,0] op_sel_hi:[1,0]
  v_pk_fma_f32 v[34:35], v[124:125], v[104:105], v[34:35] op_sel:[0,1,0] op_sel_hi:[1,1,1]
  v_pk_mul_f32 v[34:35], v[34:35], v[110:111] op_sel:[0,0] op_sel_hi:[1,0]
  v_pk_fma_f32 v[36:37], v[126:127], v[104:105], v[36:37] op_sel:[0,1,0] op_sel_hi:[1,1,1]
  v_pk_mul_f32 v[36:37], v[36:37], v[110:111] op_sel:[0,0] op_sel_hi:[1,0]
  v_pk_fma_f32 v[38:39], v[128:129], v[104:105], v[38:39] op_sel:[0,1,0] op_sel_hi:[1,1,1]
  v_pk_mul_f32 v[38:39], v[38:39], v[110:111] op_sel:[0,0] op_sel_hi:[1,0]
  v_cvt_pk_bf16_f32 v152, v32, v33
  v_cvt_pk_bf16_f32 v153, v34, v35
  v_cvt_pk_bf16_f32 v154, v36, v37
  v_cvt_pk_bf16_f32 v155, v38, v39
  v_pk_fma_f32 v[40:41], v[122:123], v[106:107], v[40:41] op_sel:[0,0,0] op_sel_hi:[1,0,1]
  v_pk_mul_f32 v[40:41], v[40:41], v[110:111] op_sel:[0,1] op_sel_hi:[1,1]
  v_pk_fma_f32 v[42:43], v[124:125], v[106:107], v[42:43] op_sel:[0,0,0] op_sel_hi:[1,0,1]
  v_pk_mul_f32 v[42:43], v[42:43], v[110:111] op_sel:[0,1] op_sel_hi:[1,1]
  v_pk_fma_f32 v[44:45], v[126:127], v[106:107], v[44:45] op_sel:[0,0,0] op_sel_hi:[1,0,1]
  v_pk_mul_f32 v[44:45], v[44:45], v[110:111] op_sel:[0,1] op_sel_hi:[1,1]
  v_pk_fma_f32 v[46:47], v[128:129], v[106:107], v[46:47] op_sel:[0,0,0] op_sel_hi:[1,0,1]
  v_pk_mul_f32 v[46:47], v[46:47], v[110:111] op_sel:[0,1] op_sel_hi:[1,1]
  v_cvt_pk_bf16_f32 v156, v40, v41
  v_cvt_pk_bf16_f32 v157, v42, v43
  v_cvt_pk_bf16_f32 v158, v44, v45
  v_cvt_pk_bf16_f32 v159, v46, v47
  s_waitcnt lgkmcnt(0)
  s_barrier
  ds_read_b128 v[148:151], v240
  ds_read_b64 v[168:169], v239 offset:1024
  ds_read_b64 v[178:179], v239 offset:1536
  v_pk_fma_f32 v[8:9], v[114:115], v[106:107], v[8:9] op_sel:[0,0,0] op_sel_hi:[1,0,1]
  v_pk_fma_f32 v[10:11], v[116:117], v[106:107], v[10:11] op_sel:[0,0,0] op_sel_hi:[1,0,1]
  v_pk_fma_f32 v[12:13], v[118:119], v[106:107], v[12:13] op_sel:[0,0,0] op_sel_hi:[1,0,1]
  v_pk_fma_f32 v[14:15], v[120:121], v[106:107], v[14:15] op_sel:[0,0,0] op_sel_hi:[1,0,1]
  v_cvt_pk_bf16_f32 v136, v8, v9
  v_cvt_pk_bf16_f32 v137, v10, v11
  v_cvt_pk_bf16_f32 v138, v12, v13
  v_cvt_pk_bf16_f32 v139, v14, v15
  v_pk_fma_f32 v[48:49], v[122:123], v[106:107], v[48:49] op_sel:[0,1,0] op_sel_hi:[1,1,1]
  v_pk_mul_f32 v[48:49], v[48:49], v[112:113] op_sel:[0,0] op_sel_hi:[1,0]
  v_pk_fma_f32 v[50:51], v[124:125], v[106:107], v[50:51] op_sel:[0,1,0] op_sel_hi:[1,1,1]
  v_pk_mul_f32 v[50:51], v[50:51], v[112:113] op_sel:[0,0] op_sel_hi:[1,0]
  v_pk_fma_f32 v[52:53], v[126:127], v[106:107], v[52:53] op_sel:[0,1,0] op_sel_hi:[1,1,1]
  v_pk_mul_f32 v[52:53], v[52:53], v[112:113] op_sel:[0,0] op_sel_hi:[1,0]
  v_pk_fma_f32 v[54:55], v[128:129], v[106:107], v[54:55] op_sel:[0,1,0] op_sel_hi:[1,1,1]
  v_pk_mul_f32 v[54:55], v[54:55], v[112:113] op_sel:[0,0] op_sel_hi:[1,0]
  v_cvt_pk_bf16_f32 v160, v48, v49
  v_cvt_pk_bf16_f32 v161, v50, v51
  v_cvt_pk_bf16_f32 v162, v52, v53
  v_cvt_pk_bf16_f32 v163, v54, v55
  v_pk_fma_f32 v[16:17], v[114:115], v[106:107], v[16:17] op_sel:[0,1,0] op_sel_hi:[1,1,1]
  v_pk_fma_f32 v[18:19], v[116:117], v[106:107], v[18:19] op_sel:[0,1,0] op_sel_hi:[1,1,1]
  v_pk_fma_f32 v[20:21], v[118:119], v[106:107], v[20:21] op_sel:[0,1,0] op_sel_hi:[1,1,1]
  v_pk_fma_f32 v[22:23], v[120:121], v[106:107], v[22:23] op_sel:[0,1,0] op_sel_hi:[1,1,1]
  v_cvt_pk_bf16_f32 v140, v16, v17
  v_cvt_pk_bf16_f32 v141, v18, v19
  v_cvt_pk_bf16_f32 v142, v20, v21
  v_cvt_pk_bf16_f32 v143, v22, v23
  v_pk_fma_f32 v[56:57], v[122:123], v[108:109], v[56:57] op_sel:[0,0,0] op_sel_hi:[1,0,1]
  v_pk_mul_f32 v[56:57], v[56:57], v[112:113] op_sel:[0,1] op_sel_hi:[1,1]
  v_pk_fma_f32 v[58:59], v[124:125], v[108:109], v[58:59] op_sel:[0,0,0] op_sel_hi:[1,0,1]
  v_pk_mul_f32 v[58:59], v[58:59], v[112:113] op_sel:[0,1] op_sel_hi:[1,1]
  v_pk_fma_f32 v[60:61], v[126:127], v[108:109], v[60:61] op_sel:[0,0,0] op_sel_hi:[1,0,1]
  v_pk_mul_f32 v[60:61], v[60:61], v[112:113] op_sel:[0,1] op_sel_hi:[1,1]
  v_pk_fma_f32 v[62:63], v[128:129], v[108:109], v[62:63] op_sel:[0,0,0] op_sel_hi:[1,0,1]
  v_pk_mul_f32 v[62:63], v[62:63], v[112:113] op_sel:[0,1] op_sel_hi:[1,1]
  v_cvt_pk_bf16_f32 v164, v56, v57
  v_cvt_pk_bf16_f32 v165, v58, v59
  v_cvt_pk_bf16_f32 v166, v60, v61
  v_cvt_pk_bf16_f32 v167, v62, v63
  v_pk_fma_f32 v[24:25], v[114:115], v[108:109], v[24:25] op_sel:[0,0,0] op_sel_hi:[1,0,1]
  v_pk_fma_f32 v[26:27], v[116:117], v[108:109], v[26:27] op_sel:[0,0,0] op_sel_hi:[1,0,1]
  v_pk_fma_f32 v[28:29], v[118:119], v[108:109], v[28:29] op_sel:[0,0,0] op_sel_hi:[1,0,1]
  v_pk_fma_f32 v[30:31], v[120:121], v[108:109], v[30:31] op_sel:[0,0,0] op_sel_hi:[1,0,1]
  v_cvt_pk_bf16_f32 v144, v24, v25
  v_cvt_pk_bf16_f32 v145, v26, v27
  v_cvt_pk_bf16_f32 v146, v28, v29
  v_cvt_pk_bf16_f32 v147, v30, v31
  v_pk_fma_f32 v[0:1], v[114:115], v[104:105], v[0:1] op_sel:[0,1,0] op_sel_hi:[1,1,1]
  v_pk_fma_f32 v[2:3], v[116:117], v[104:105], v[2:3] op_sel:[0,1,0] op_sel_hi:[1,1,1]
  v_pk_fma_f32 v[4:5], v[118:119], v[104:105], v[4:5] op_sel:[0,1,0] op_sel_hi:[1,1,1]
  v_pk_fma_f32 v[6:7], v[120:121], v[104:105], v[6:7] op_sel:[0,1,0] op_sel_hi:[1,1,1]
  v_cvt_pk_bf16_f32 v132, v0, v1
  v_cvt_pk_bf16_f32 v133, v2, v3
  v_cvt_pk_bf16_f32 v134, v4, v5
  v_cvt_pk_bf16_f32 v135, v6, v7
  v_mul_f32 v189, s75, v111
  v_mul_f32 v190, s75, v112
  v_mul_f32 v191, s75, v113
  v_mul_f32 v188, s75, v110
  v_pk_fma_f32 v[64:65], v[200:201], v[130:131], v[64:65] op_sel:[0,0,0] op_sel_hi:[1,0,1]
  v_pk_mul_f32 v[64:65], v[64:65], v[220:221]
  v_pk_fma_f32 v[66:67], v[202:203], v[130:131], v[66:67] op_sel:[0,0,0] op_sel_hi:[1,0,1]
  v_pk_mul_f32 v[66:67], v[66:67], v[222:223]
  v_pk_fma_f32 v[68:69], v[200:201], v[130:131], v[68:69] op_sel:[0,1,0] op_sel_hi:[1,1,1]
  v_pk_mul_f32 v[68:69], v[68:69], v[220:221]
  v_pk_fma_f32 v[70:71], v[202:203], v[130:131], v[70:71] op_sel:[0,1,0] op_sel_hi:[1,1,1]
  v_pk_mul_f32 v[70:71], v[70:71], v[222:223]
  s_waitcnt lgkmcnt(0)
  v_mfma_f32_16x16x32_bf16 v[8:11], v[152:155], v[136:139], 0
  v_cvt_pk_bf16_f32 v170, v64, v65
  v_cvt_pk_bf16_f32 v171, v66, v67
  v_mfma_f32_16x16x32_bf16 v[12:15], v[156:159], v[136:139], 0
  v_cvt_pk_bf16_f32 v180, v68, v69
  v_cvt_pk_bf16_f32 v181, v70, v71
  v_mfma_f32_16x16x32_bf16 v[16:19], v[156:159], v[140:143], 0
  s_nop 1
  v_cndmask_b32 v8, v8, v9, s[94:95]
  v_mfma_f32_16x16x32_bf16 v[20:23], v[160:163], v[140:143], 0
  v_cndmask_b32 v10, v10, v11, s[94:95]
  v_mfma_f32_16x16x32_bf16 v[24:27], v[160:163], v[144:147], 0
  v_cndmask_b32 v12, v12, v13, s[94:95]
  v_cndmask_b32 v14, v14, v15, s[94:95]
  v_mfma_f32_16x16x32_bf16 v[28:31], v[164:167], v[144:147], 0
  v_cndmask_b32 v8, v8, v12, s[96:97]
  v_cndmask_b32 v10, v10, v14, s[98:99]
  v_mfma_f32_16x16x32_bf16 v[0:3], v[148:151], v[132:135], 0
  v_max_f32_e64 v9, v8, v10
  v_cndmask_b32 v16, v16, v17, s[94:95]
  v_mfma_f32_16x16x32_bf16 v[4:7], v[152:155], v[132:135], 0
  v_cndmask_b32 v18, v18, v19, s[94:95]
  v_cndmask_b32 v20, v20, v21, s[94:95]
  v_cndmask_b32 v22, v22, v23, s[94:95]
  v_cndmask_b32 v16, v16, v20, s[96:97]
  v_cndmask_b32 v18, v18, v22, s[98:99]
  v_max_f32_e64 v17, v16, v18
  v_cndmask_b32 v24, v24, v25, s[94:95]
  v_cndmask_b32 v26, v26, v27, s[94:95]
  v_cndmask_b32 v28, v28, v29, s[94:95]
  v_cndmask_b32 v30, v30, v31, s[94:95]
  v_cndmask_b32 v24, v24, v28, s[96:97]
  v_cndmask_b32 v26, v26, v30, s[98:99]
  v_max_f32_e64 v25, v24, v26
  v_cndmask_b32 v0, v0, v1, s[94:95]
  v_cndmask_b32 v2, v2, v3, s[94:95]
  v_cndmask_b32 v4, v4, v5, s[94:95]
  v_cndmask_b32 v6, v6, v7, s[94:95]
  v_cndmask_b32 v0, v0, v4, s[96:97]
  v_cndmask_b32 v2, v2, v6, s[98:99]
  v_max_f32 v1, v0, v2
  v_permlane32_swap_b32 v9, v17
  v_pk_fma_f32 v[72:73], v[204:205], v[130:131], v[72:73] op_sel:[0,0,0] op_sel_hi:[1,0,1]
  v_pk_mul_f32 v[72:73], v[72:73], v[224:225]
  v_permlane32_swap_b32_e64 v25, v1
  v_pk_fma_f32 v[74:75], v[206:207], v[130:131], v[74:75] op_sel:[0,0,0] op_sel_hi:[1,0,1]
  v_pk_mul_f32 v[74:75], v[74:75], v[226:227]
  v_max_f32_e64 v9, v9, v17
  v_pk_fma_f32 v[76:77], v[204:205], v[130:131], v[76:77] op_sel:[0,1,0] op_sel_hi:[1,1,1]
  v_pk_mul_f32 v[76:77], v[76:77], v[224:225]
  v_max_f32_e64 v25, v25, v1
  v_pk_fma_f32 v[78:79], v[206:207], v[130:131], v[78:79] op_sel:[0,1,0] op_sel_hi:[1,1,1]
  v_pk_mul_f32 v[78:79], v[78:79], v[226:227]
  v_permlane16_swap_b32_e64 v9, v25
  v_pk_fma_f32 v[80:81], v[208:209], v[130:131], v[80:81] op_sel:[0,0,0] op_sel_hi:[1,0,1]
  v_pk_mul_f32 v[80:81], v[80:81], v[228:229]
  v_max_f32_e64 v9, v9, v25
  v_pk_fma_f32 v[82:83], v[210:211], v[130:131], v[82:83] op_sel:[0,0,0] op_sel_hi:[1,0,1]
  v_pk_mul_f32 v[82:83], v[82:83], v[230:231]
  v_mov_b32_e64 v17, v9
  v_pk_fma_f32 v[84:85], v[208:209], v[130:131], v[84:85] op_sel:[0,1,0] op_sel_hi:[1,1,1]
  v_pk_mul_f32 v[84:85], v[84:85], v[228:229]
  v_permlane32_swap_b32_e64 v9, v17
  v_pk_fma_f32 v[86:87], v[210:211], v[130:131], v[86:87] op_sel:[0,1,0] op_sel_hi:[1,1,1]
  v_pk_mul_f32 v[86:87], v[86:87], v[230:231]
  v_mov_b32_e64 v25, v9
  v_pk_fma_f32 v[88:89], v[212:213], v[130:131], v[88:89] op_sel:[0,0,0] op_sel_hi:[1,0,1]
  v_pk_mul_f32 v[88:89], v[88:89], v[232:233]
  v_mov_b32_e64 v1, v17
  v_pk_fma_f32 v[90:91], v[214:215], v[130:131], v[90:91] op_sel:[0,0,0] op_sel_hi:[1,0,1]
  v_pk_mul_f32 v[90:91], v[90:91], v[234:235]
  v_permlane16_swap_b32_e64 v9, v25
  v_pk_fma_f32 v[92:93], v[212:213], v[130:131], v[92:93] op_sel:[0,1,0] op_sel_hi:[1,1,1]
  v_pk_mul_f32 v[92:93], v[92:93], v[232:233]
  v_permlane16_swap_b32_e64 v17, v1
  v_pk_fma_f32 v[94:95], v[214:215], v[130:131], v[94:95] op_sel:[0,1,0] op_sel_hi:[1,1,1]
  v_pk_mul_f32 v[94:95], v[94:95], v[234:235]
  v_cvt_pk_bf16_f32 v172, v72, v73
  v_cvt_pk_bf16_f32 v173, v74, v75
  v_cvt_pk_bf16_f32 v182, v76, v77
  v_cvt_pk_bf16_f32 v183, v78, v79
  v_cvt_pk_bf16_f32 v174, v80, v81
  v_cvt_pk_bf16_f32 v175, v82, v83
  v_cvt_pk_bf16_f32 v184, v84, v85
  v_cvt_pk_bf16_f32 v185, v86, v87
  v_cvt_pk_bf16_f32 v176, v88, v89
  v_cvt_pk_bf16_f32 v177, v90, v91
  v_cvt_pk_bf16_f32 v186, v92, v93
  v_cvt_pk_bf16_f32 v187, v94, v95
  v_mul_f32 v12, v9, v189
  v_mul_f32 v20, v17, v190
  v_mul_f32 v28, v25, v191
  v_mul_f32 v4, v1, v188
  v_fma_f32 v8, v8, v189, -v12
  v_fma_f32 v10, v10, v189, -v12
  v_fma_f32 v16, v16, v190, -v20
  v_fma_f32 v18, v18, v190, -v20
  v_fma_f32 v24, v24, v191, -v28
  v_fma_f32 v26, v26, v191, -v28
  v_fma_f32 v0, v0, v188, -v4
  v_fma_f32 v2, v2, v188, -v4
  v_exp_f32 v8, v8
  v_exp_f32 v10, v10
  v_exp_f32 v16, v16
  v_exp_f32 v18, v18
  v_exp_f32 v24, v24
  v_exp_f32 v26, v26
  v_exp_f32 v0, v0
  v_exp_f32 v2, v2
  v_cvt_pk_bf16_f32 v13, v8, v10
  v_cvt_pk_bf16_f32 v21, v16, v18
  v_cvt_pk_bf16_f32 v29, v24, v26
  v_cvt_pk_bf16_f32 v5, v0, v2
  v_perm_b32 v40, v13, v13, v192
  v_perm_b32 v41, v13, v13, v193
  v_perm_b32 v42, v13, v13, v194
  v_perm_b32 v43, v13, v13, v195
  v_perm_b32 v48, v21, v21, v192
  v_perm_b32 v49, v21, v21, v193
  v_mfma_f32_16x16x32_bf16 v[12:15], v[248:251], v[40:43], 0
  v_perm_b32 v50, v21, v21, v194
  v_perm_b32 v51, v21, v21, v195
  v_mfma_f32_16x16x32_bf16 v[72:75], v[170:173], v[40:43], 0
  v_perm_b32 v56, v29, v29, v192
  v_perm_b32 v57, v29, v29, v193
  v_mfma_f32_16x16x32_bf16 v[76:79], v[180:183], v[40:43], 0
  v_perm_b32 v58, v29, v29, v194
  v_perm_b32 v59, v29, v29, v195
  v_mfma_f32_16x16x32_bf16 v[20:23], v[248:251], v[48:51], 0
  v_rcp_f32_e64 v12, v12
  v_mfma_f32_16x16x32_bf16 v[80:83], v[172:175], v[48:51], 0
  v_perm_b32 v32, v5, v5, v192
  v_perm_b32 v33, v5, v5, v193
  v_mfma_f32_16x16x32_bf16 v[84:87], v[182:185], v[48:51], 0
  v_perm_b32 v34, v5, v5, v194
  v_perm_b32 v35, v5, v5, v195
  v_mfma_f32_16x16x32_bf16 v[28:31], v[248:251], v[56:59], 0
  v_rcp_f32_e64 v20, v20
  v_mfma_f32_16x16x32_bf16 v[88:91], v[174:177], v[56:59], 0
  v_mfma_f32_16x16x32_bf16 v[92:95], v[184:187], v[56:59], 0
  v_mfma_f32_16x16x32_bf16 v[4:7], v[248:251], v[32:35], 0
  v_mfma_f32_16x16x32_bf16 v[64:67], v[168:171], v[32:35], 0
  v_mfma_f32_16x16x32_bf16 v[68:71], v[178:181], v[32:35], 0
  s_nop 1
  v_rcp_f32 v28, v28
  v_pk_mul_f32 v[72:73], v[72:73], v[12:13] op_sel:[0,0] op_sel_hi:[1,0]
  v_pk_mul_f32 v[74:75], v[74:75], v[12:13] op_sel:[0,0] op_sel_hi:[1,0]
  v_pk_mul_f32 v[76:77], v[76:77], v[12:13] op_sel:[0,0] op_sel_hi:[1,0]
  v_pk_mul_f32 v[78:79], v[78:79], v[12:13] op_sel:[0,0] op_sel_hi:[1,0]
  v_cvt_pk_bf16_f32 v44, v72, v73
  v_rcp_f32_e64 v4, v4
  v_cvt_pk_bf16_f32 v45, v74, v75
  v_cvt_pk_bf16_f32 v46, v76, v77
  v_cvt_pk_bf16_f32 v47, v78, v79
  buffer_store_dwordx4 v[44:47], v238, s[12:15], 0 offen offset:2048 sc1
  v_pk_mul_f32 v[80:81], v[80:81], v[20:21] op_sel:[0,0] op_sel_hi:[1,0]
  v_pk_mul_f32 v[82:83], v[82:83], v[20:21] op_sel:[0,0] op_sel_hi:[1,0]
  v_pk_mul_f32 v[84:85], v[84:85], v[20:21] op_sel:[0,0] op_sel_hi:[1,0]
  v_pk_mul_f32 v[86:87], v[86:87], v[20:21] op_sel:[0,0] op_sel_hi:[1,0]
  v_cvt_pk_bf16_f32 v52, v80, v81
  v_cvt_pk_bf16_f32 v53, v82, v83
  v_cvt_pk_bf16_f32 v54, v84, v85
  v_cvt_pk_bf16_f32 v55, v86, v87
  buffer_store_dwordx4 v[52:55], v238, s[12:15], s76 offen offset:0 sc1
  v_pk_mul_f32 v[88:89], v[88:89], v[28:29] op_sel:[0,0] op_sel_hi:[1,0]
  v_pk_mul_f32 v[90:91], v[90:91], v[28:29] op_sel:[0,0] op_sel_hi:[1,0]
  v_pk_mul_f32 v[92:93], v[92:93], v[28:29] op_sel:[0,0] op_sel_hi:[1,0]
  v_pk_mul_f32 v[94:95], v[94:95], v[28:29] op_sel:[0,0] op_sel_hi:[1,0]
  v_cvt_pk_bf16_f32 v60, v88, v89
  v_cvt_pk_bf16_f32 v61, v90, v91
  v_cvt_pk_bf16_f32 v62, v92, v93
  v_cvt_pk_bf16_f32 v63, v94, v95
  buffer_store_dwordx4 v[60:63], v238, s[12:15], s76 offen offset:2048 sc1
  v_pk_mul_f32 v[64:65], v[64:65], v[4:5] op_sel:[0,0] op_sel_hi:[1,0]
  v_pk_mul_f32 v[66:67], v[66:67], v[4:5] op_sel:[0,0] op_sel_hi:[1,0]
  v_pk_mul_f32 v[68:69], v[68:69], v[4:5] op_sel:[0,0] op_sel_hi:[1,0]
  v_pk_mul_f32 v[70:71], v[70:71], v[4:5] op_sel:[0,0] op_sel_hi:[1,0]
  v_cvt_pk_bf16_f32 v36, v64, v65
  v_cvt_pk_bf16_f32 v37, v66, v67
  v_cvt_pk_bf16_f32 v38, v68, v69
  v_cvt_pk_bf16_f32 v39, v70, v71
  buffer_store_dwordx4 v[36:39], v238, s[12:15], 0 offen offset:0 sc1
  s_branch c_g2
c_g2:
  v_and_b32 v246, 15, v247
  v_lshrrev_b32 v245, 4, v247
  s_lshl_b32 s77, s53, 7
  s_lshl_b32 s57, s55, 5
  s_add_u32 s77, s77, s57
  v_and_b32 v3, 1, v245
  v_lshlrev_b32 v3, 5, v3
  v_lshrrev_b32_e64 v4, 1, v245
  v_lshl_add_u32 v3, v4, 4, v3
  v_add_u32_e64 v1, s77, v246
  v_lshl_add_u32 v1, v1, 11, v3
  s_lshl_b32 s57, s54, 7
  v_add_u32_e64 v1, s57, v1
  s_lshl_b32 s57, s53, 4
  s_add_u32 s57, s57, s54
  s_lshl_b32 s57, s57, 14
  s_lshl_b32 s58, s55, 12
  s_add_u32 s57, s57, s58
  v_lshl_add_u32 v2, v246, 6, v3
  v_add_u32 v2, s57, v2
  s_cmp_eq_u32 s50, 0
  s_cselect_b64 vcc, -1, 0
  s_movk_i32 s59, 2048
  s_cselect_b32 s84, 32768, s59
  s_cselect_b32 s85, 64, 1024
  v_cndmask_b32_e64 v233, v2, v1, vcc
  s_cmp_eq_u32 s50, 3
  s_cselect_b64 vcc, -1, 0
  s_cselect_b32 s86, 32768, s59
  s_cselect_b32 s87, 64, 1024
  v_cndmask_b32 v234, v2, v1, vcc
  s_add_u32 s58, s84, s85
  buffer_load_dwordx4 v[80:83], v233, s[4:7], 0 offen
  buffer_load_dwordx4 v[84:87], v233, s[4:7], s85 offen
  buffer_load_dwordx4 v[88:91], v233, s[4:7], s84 offen
  buffer_load_dwordx4 v[92:95], v233, s[4:7], s58 offen
  s_lshl_b32 s57, s50, 1
  s_add_u32 s57, s57, 0
  s_lshl_b32 s57, s57, 4
  s_add_u32 s57, s57, s51
  s_mul_i32 s57, s57, 16384
  s_mul_i32 s58, s52, 1024
  s_add_u32 s59, s57, s58
  v_mov_b32 v239, s93
  v_mov_b32 v236, 156288
  v_mov_b32 v237, 1
  v_mov_b32 v240, 0
  s_mov_b64 exec, 1
  s_waitcnt vmcnt(4)
  ds_add_rtn_u32 v238, v236, v237
  s_waitcnt lgkmcnt(0)
  v_readfirstlane_b32 s57, v238
  s_nop 3
  s_and_b32 s57, s57, 3
  s_cmp_eq_u32 s57, 3
  s_cbranch_scc0 sig_o_skip
  buffer_store_dword v239, v240, s[32:35], s59 offen sc1
sig_o_skip:
  s_mov_b64 exec, -1
  v_lshrrev_b32 v3, 2, v246
  v_and_b32 v4, 3, v246
  v_lshrrev_b32 v5, 1, v3
  v_and_b32_e64 v6, 1, v245
  v_lshl_or_b32 v5, v6, 1, v5
  v_lshlrev_b32 v5, 1, v5
  v_lshrrev_b32 v6, 1, v4
  v_xor_b32 v6, v6, v5
  v_lshlrev_b32 v6, 4, v6
  v_and_b32_e64 v7, 1, v4
  v_lshl_add_u32 v6, v7, 3, v6
  v_lshl_add_u32 v7, v245, 2, v3
  v_lshl_add_u32 v6, v7, 7, v6
  v_xor_b32 v224, 0, v6
  v_xor_b32 v225, 32, v6
  v_xor_b32_e64 v226, 64, v6
  v_xor_b32 v227, 96, v6
  v_add_u32 v224, 8192, v224
  v_add_u32 v228, 0x10000, v224
  v_add_u32 v225, 8192, v225
  v_add_u32 v229, 0x10000, v225
  v_add_u32 v226, 8192, v226
  v_add_u32 v230, 0x10000, v226
  v_add_u32 v227, 8192, v227
  v_add_u32 v231, 0x10000, v227
  v_add_u32 v235, s77, v246
  v_lshlrev_b32 v235, 3, v235
  v_lshlrev_b32 v232, 4, v247
  s_lshl_b32 s57, s55, 12
  v_add_u32_e64 v232, s57, v232
  s_lshl_b32 s78, s53, 18
  s_mov_b32 s88, s78
  s_add_u32 s78, s78, 65536
  s_waitcnt vmcnt(0)
  v_lshlrev_b32 v0, 16, v80
  v_and_b32 v1, 0xffff0000, v80
  v_lshlrev_b32_e64 v2, 16, v81
  v_and_b32 v3, 0xffff0000, v81
  v_lshlrev_b32_e64 v4, 16, v82
  v_and_b32 v5, 0xffff0000, v82
  v_lshlrev_b32_e64 v6, 16, v83
  v_and_b32 v7, 0xffff0000, v83
  v_lshlrev_b32_e64 v8, 16, v84
  v_and_b32 v9, 0xffff0000, v84
  v_lshlrev_b32_e64 v10, 16, v85
  v_and_b32 v11, 0xffff0000, v85
  v_lshlrev_b32_e64 v12, 16, v86
  v_and_b32 v13, 0xffff0000, v86
  v_lshlrev_b32_e64 v14, 16, v87
  v_and_b32 v15, 0xffff0000, v87
  v_lshlrev_b32_e64 v16, 16, v88
  v_and_b32 v17, 0xffff0000, v88
  v_lshlrev_b32_e64 v18, 16, v89
  v_and_b32 v19, 0xffff0000, v89
  v_lshlrev_b32_e64 v20, 16, v90
  v_and_b32 v21, 0xffff0000, v90
  v_lshlrev_b32_e64 v22, 16, v91
  v_and_b32 v23, 0xffff0000, v91
  v_lshlrev_b32_e64 v24, 16, v92
  v_and_b32 v25, 0xffff0000, v92
  v_lshlrev_b32_e64 v26, 16, v93
  v_and_b32 v27, 0xffff0000, v93
  v_lshlrev_b32_e64 v28, 16, v94
  v_and_b32 v29, 0xffff0000, v94
  v_lshlrev_b32_e64 v30, 16, v95
  v_and_b32 v31, 0xffff0000, v95
  v_permlane16_swap_b32 v0, v4
  v_permlane16_swap_b32 v1, v5
  v_permlane16_swap_b32 v2, v6
  v_permlane16_swap_b32 v3, v7
  v_permlane16_swap_b32 v8, v12
  v_permlane16_swap_b32 v9, v13
  v_permlane16_swap_b32 v10, v14
  v_permlane16_swap_b32 v11, v15
  v_permlane16_swap_b32 v16, v20
  v_permlane16_swap_b32 v17, v21
  v_permlane16_swap_b32 v18, v22
  v_permlane16_swap_b32 v19, v23
  v_permlane16_swap_b32 v24, v28
  v_permlane16_swap_b32 v25, v29
  v_permlane16_swap_b32 v26, v30
  v_permlane16_swap_b32_e64 v27, v31
  s_barrier
  buffer_load_dwordx4 v[96:99], v232, s[12:15], s78 offen offset:0
  buffer_load_dwordx4 v[100:103], v232, s[12:15], s78 offen offset:2048
  buffer_load_dwordx4 v[104:107], v232, s[12:15], s78 offen offset:1024
  buffer_load_dwordx4 v[108:111], v232, s[12:15], s78 offen offset:3072
  s_add_u32 s78, s88, 98304
  buffer_load_dwordx4 v[112:115], v232, s[12:15], s78 offen offset:0
  buffer_load_dwordx4 v[116:119], v232, s[12:15], s78 offen offset:2048
  buffer_load_dwordx4 v[120:123], v232, s[12:15], s78 offen offset:1024
  buffer_load_dwordx4 v[124:127], v232, s[12:15], s78 offen offset:3072
  ds_read_b64_tr_b16 v[32:33], v224 offset:32768
  ds_read_b64_tr_b16 v[34:35], v224 offset:34816
  ds_read_b64_tr_b16 v[36:37], v225 offset:32768
  ds_read_b64_tr_b16 v[38:39], v225 offset:34816
  ds_read_b64_tr_b16 v[40:41], v226 offset:32768
  ds_read_b64_tr_b16 v[42:43], v226 offset:34816
  ds_read_b64_tr_b16 v[44:45], v227 offset:32768
  ds_read_b64_tr_b16 v[46:47], v227 offset:34816
  ds_read_b64_tr_b16 v[48:49], v224 offset:36864
  ds_read_b64_tr_b16 v[50:51], v224 offset:38912
  ds_read_b64_tr_b16 v[52:53], v225 offset:36864
  ds_read_b64_tr_b16 v[54:55], v225 offset:38912
  ds_read_b64_tr_b16 v[56:57], v226 offset:36864
  ds_read_b64_tr_b16 v[58:59], v226 offset:38912
  ds_read_b64_tr_b16 v[60:61], v227 offset:36864
  ds_read_b64_tr_b16 v[62:63], v227 offset:38912
  s_waitcnt vmcnt(6) lgkmcnt(8)
  v_mfma_f32_16x16x32_bf16 v[0:3], v[32:35], v[96:99], v[0:3]
  ds_read_b64_tr_b16 v[64:65], v224 offset:49152
  ds_read_b64_tr_b16 v[66:67], v224 offset:51200
  v_mfma_f32_16x16x32_bf16 v[16:19], v[32:35], v[100:103], v[16:19]
  ds_read_b64_tr_b16 v[68:69], v225 offset:49152
  ds_read_b64_tr_b16 v[70:71], v225 offset:51200
  v_mfma_f32_16x16x32_bf16 v[4:7], v[36:39], v[96:99], v[4:7]
  s_add_u32 s78, s88, 131072
  buffer_load_dwordx4 v[128:131], v232, s[12:15], s78 offen offset:0
  v_mfma_f32_16x16x32_bf16 v[20:23], v[36:39], v[100:103], v[20:23]
  buffer_load_dwordx4 v[132:135], v232, s[12:15], s78 offen offset:2048
  buffer_load_dwordx4 v[136:139], v232, s[12:15], s78 offen offset:1024
  v_mfma_f32_16x16x32_bf16 v[8:11], v[40:43], v[96:99], v[8:11]
  buffer_load_dwordx4 v[140:143], v232, s[12:15], s78 offen offset:3072
  ds_read_b64_tr_b16 v[72:73], v226 offset:49152
  v_mfma_f32_16x16x32_bf16 v[24:27], v[40:43], v[100:103], v[24:27]
  ds_read_b64_tr_b16 v[74:75], v226 offset:51200
  ds_read_b64_tr_b16 v[76:77], v227 offset:49152
  v_mfma_f32_16x16x32_bf16 v[12:15], v[44:47], v[96:99], v[12:15]
  ds_read_b64_tr_b16 v[78:79], v227 offset:51200
  v_mfma_f32_16x16x32_bf16 v[28:31], v[44:47], v[100:103], v[28:31]
  s_waitcnt vmcnt(8) lgkmcnt(8)
  v_mfma_f32_16x16x32_bf16 v[0:3], v[48:51], v[104:107], v[0:3]
  ds_read_b64_tr_b16 v[32:33], v224 offset:53248
  ds_read_b64_tr_b16 v[34:35], v224 offset:55296
  v_mfma_f32_16x16x32_bf16 v[16:19], v[48:51], v[108:111], v[16:19]
  ds_read_b64_tr_b16 v[36:37], v225 offset:53248
  ds_read_b64_tr_b16 v[38:39], v225 offset:55296
  v_mfma_f32_16x16x32_bf16 v[4:7], v[52:55], v[104:107], v[4:7]
  s_add_u32 s78, s88, 163840
  buffer_load_dwordx4 v[144:147], v232, s[12:15], s78 offen offset:0
  v_mfma_f32_16x16x32_bf16 v[20:23], v[52:55], v[108:111], v[20:23]
  buffer_load_dwordx4 v[148:151], v232, s[12:15], s78 offen offset:2048
  buffer_load_dwordx4 v[152:155], v232, s[12:15], s78 offen offset:1024
  v_mfma_f32_16x16x32_bf16 v[8:11], v[56:59], v[104:107], v[8:11]
  buffer_load_dwordx4 v[156:159], v232, s[12:15], s78 offen offset:3072
  ds_read_b64_tr_b16 v[40:41], v226 offset:53248
  v_mfma_f32_16x16x32_bf16 v[24:27], v[56:59], v[108:111], v[24:27]
  ds_read_b64_tr_b16 v[42:43], v226 offset:55296
  ds_read_b64_tr_b16 v[44:45], v227 offset:53248
  v_mfma_f32_16x16x32_bf16 v[12:15], v[60:63], v[104:107], v[12:15]
  ds_read_b64_tr_b16 v[46:47], v227 offset:55296
  v_mfma_f32_16x16x32_bf16 v[28:31], v[60:63], v[108:111], v[28:31]
  s_waitcnt vmcnt(10) lgkmcnt(8)
  s_barrier
  v_mfma_f32_16x16x32_bf16 v[0:3], v[64:67], v[112:115], v[0:3]
  ds_read_b64_tr_b16 v[48:49], v228 offset:0
  ds_read_b64_tr_b16 v[50:51], v228 offset:2048
  v_mfma_f32_16x16x32_bf16 v[16:19], v[64:67], v[116:119], v[16:19]
  ds_read_b64_tr_b16 v[52:53], v229 offset:0
  ds_read_b64_tr_b16 v[54:55], v229 offset:2048
  v_mfma_f32_16x16x32_bf16 v[4:7], v[68:71], v[112:115], v[4:7]
  s_add_u32 s78, s88, 114688
  buffer_load_dwordx4 v[160:163], v232, s[12:15], s78 offen offset:0
  v_mfma_f32_16x16x32_bf16 v[20:23], v[68:71], v[116:119], v[20:23]
  buffer_load_dwordx4 v[164:167], v232, s[12:15], s78 offen offset:2048
  ds_read_b64_tr_b16 v[56:57], v230 offset:0
  v_mfma_f32_16x16x32_bf16 v[8:11], v[72:75], v[112:115], v[8:11]
  ds_read_b64_tr_b16 v[58:59], v230 offset:2048
  ds_read_b64_tr_b16 v[60:61], v231 offset:0
  v_mfma_f32_16x16x32_bf16 v[24:27], v[72:75], v[116:119], v[24:27]
  ds_read_b64_tr_b16 v[62:63], v231 offset:2048
  v_mfma_f32_16x16x32_bf16 v[12:15], v[76:79], v[112:115], v[12:15]
  v_mfma_f32_16x16x32_bf16 v[28:31], v[76:79], v[116:119], v[28:31]
  s_waitcnt vmcnt(10) lgkmcnt(8)
  v_mfma_f32_16x16x32_bf16 v[0:3], v[32:35], v[120:123], v[0:3]
  ds_read_b64_tr_b16 v[64:65], v228 offset:4096
  ds_read_b64_tr_b16 v[66:67], v228 offset:6144
  v_mfma_f32_16x16x32_bf16 v[16:19], v[32:35], v[124:127], v[16:19]
  ds_read_b64_tr_b16 v[68:69], v229 offset:4096
  ds_read_b64_tr_b16 v[70:71], v229 offset:6144
  v_mfma_f32_16x16x32_bf16 v[4:7], v[36:39], v[120:123], v[4:7]
  buffer_load_dwordx4 v[168:171], v232, s[12:15], s78 offen offset:1024
  buffer_load_dwordx4 v[172:175], v232, s[12:15], s78 offen offset:3072
  v_mfma_f32_16x16x32_bf16 v[20:23], v[36:39], v[124:127], v[20:23]
  ds_read_b64_tr_b16 v[72:73], v230 offset:4096
  ds_read_b64_tr_b16 v[74:75], v230 offset:6144
  v_mfma_f32_16x16x32_bf16 v[8:11], v[40:43], v[120:123], v[8:11]
  ds_read_b64_tr_b16 v[76:77], v231 offset:4096
  ds_read_b64_tr_b16 v[78:79], v231 offset:6144
  v_mfma_f32_16x16x32_bf16 v[24:27], v[40:43], v[124:127], v[24:27]
  v_mfma_f32_16x16x32_bf16 v[12:15], v[44:47], v[120:123], v[12:15]
  v_mfma_f32_16x16x32_bf16 v[28:31], v[44:47], v[124:127], v[28:31]
  s_waitcnt vmcnt(10) lgkmcnt(8)
  v_mfma_f32_16x16x32_bf16 v[0:3], v[48:51], v[128:131], v[0:3]
  ds_read_b64_tr_b16 v[32:33], v228 offset:16384
  ds_read_b64_tr_b16 v[34:35], v228 offset:18432
  v_mfma_f32_16x16x32_bf16 v[16:19], v[48:51], v[132:135], v[16:19]
  ds_read_b64_tr_b16 v[36:37], v229 offset:16384
  ds_read_b64_tr_b16 v[38:39], v229 offset:18432
  v_mfma_f32_16x16x32_bf16 v[4:7], v[52:55], v[128:131], v[4:7]
  s_add_u32 s78, s88, 0
  buffer_load_dwordx4 v[176:179], v232, s[12:15], s78 offen offset:0
  v_mfma_f32_16x16x32_bf16 v[20:23], v[52:55], v[132:135], v[20:23]
  buffer_load_dwordx4 v[180:183], v232, s[12:15], s78 offen offset:2048
  ds_read_b64_tr_b16 v[40:41], v230 offset:16384
  v_mfma_f32_16x16x32_bf16 v[8:11], v[56:59], v[128:131], v[8:11]
  ds_read_b64_tr_b16 v[42:43], v230 offset:18432
  ds_read_b64_tr_b16 v[44:45], v231 offset:16384
  v_mfma_f32_16x16x32_bf16 v[24:27], v[56:59], v[132:135], v[24:27]
  ds_read_b64_tr_b16 v[46:47], v231 offset:18432
  v_mfma_f32_16x16x32_bf16 v[12:15], v[60:63], v[128:131], v[12:15]
  v_mfma_f32_16x16x32_bf16 v[28:31], v[60:63], v[132:135], v[28:31]
  s_waitcnt vmcnt(10) lgkmcnt(8)
  v_mfma_f32_16x16x32_bf16 v[0:3], v[64:67], v[136:139], v[0:3]
  ds_read_b64_tr_b16 v[48:49], v228 offset:20480
  ds_read_b64_tr_b16 v[50:51], v228 offset:22528
  v_mfma_f32_16x16x32_bf16 v[16:19], v[64:67], v[140:143], v[16:19]
  ds_read_b64_tr_b16 v[52:53], v229 offset:20480
  ds_read_b64_tr_b16 v[54:55], v229 offset:22528
  v_mfma_f32_16x16x32_bf16 v[4:7], v[68:71], v[136:139], v[4:7]
  buffer_load_dwordx4 v[184:187], v232, s[12:15], s78 offen offset:1024
  buffer_load_dwordx4 v[188:191], v232, s[12:15], s78 offen offset:3072
  v_mfma_f32_16x16x32_bf16 v[20:23], v[68:71], v[140:143], v[20:23]
  ds_read_b64_tr_b16 v[56:57], v230 offset:20480
  ds_read_b64_tr_b16 v[58:59], v230 offset:22528
  v_mfma_f32_16x16x32_bf16 v[8:11], v[72:75], v[136:139], v[8:11]
  ds_read_b64_tr_b16 v[60:61], v231 offset:20480
  ds_read_b64_tr_b16 v[62:63], v231 offset:22528
  v_mfma_f32_16x16x32_bf16 v[24:27], v[72:75], v[140:143], v[24:27]
  v_mfma_f32_16x16x32_bf16 v[12:15], v[76:79], v[136:139], v[12:15]
  v_mfma_f32_16x16x32_bf16 v[28:31], v[76:79], v[140:143], v[28:31]
  s_waitcnt vmcnt(10) lgkmcnt(8)
  v_mfma_f32_16x16x32_bf16 v[0:3], v[32:35], v[144:147], v[0:3]
  ds_read_b64_tr_b16 v[64:65], v224 offset:57344
  ds_read_b64_tr_b16 v[66:67], v224 offset:59392
  v_mfma_f32_16x16x32_bf16 v[16:19], v[32:35], v[148:151], v[16:19]
  ds_read_b64_tr_b16 v[68:69], v225 offset:57344
  ds_read_b64_tr_b16 v[70:71], v225 offset:59392
  v_mfma_f32_16x16x32_bf16 v[4:7], v[36:39], v[144:147], v[4:7]
  s_add_u32 s78, s88, 32768
  buffer_load_dwordx4 v[192:195], v232, s[12:15], s78 offen offset:0
  v_mfma_f32_16x16x32_bf16 v[20:23], v[36:39], v[148:151], v[20:23]
  buffer_load_dwordx4 v[196:199], v232, s[12:15], s78 offen offset:2048
  ds_read_b64_tr_b16 v[72:73], v226 offset:57344
  v_mfma_f32_16x16x32_bf16 v[8:11], v[40:43], v[144:147], v[8:11]
  ds_read_b64_tr_b16 v[74:75], v226 offset:59392
  ds_read_b64_tr_b16 v[76:77], v227 offset:57344
  v_mfma_f32_16x16x32_bf16 v[24:27], v[40:43], v[148:151], v[24:27]
  ds_read_b64_tr_b16 v[78:79], v227 offset:59392
  v_mfma_f32_16x16x32_bf16 v[12:15], v[44:47], v[144:147], v[12:15]
  v_mfma_f32_16x16x32_bf16 v[28:31], v[44:47], v[148:151], v[28:31]
  s_waitcnt vmcnt(10) lgkmcnt(8)
  v_mfma_f32_16x16x32_bf16 v[0:3], v[48:51], v[152:155], v[0:3]
  ds_read_b64_tr_b16 v[32:33], v224 offset:61440
  ds_read_b64_tr_b16 v[34:35], v224 offset:63488
  v_mfma_f32_16x16x32_bf16 v[16:19], v[48:51], v[156:159], v[16:19]
  ds_read_b64_tr_b16 v[36:37], v225 offset:61440
  ds_read_b64_tr_b16 v[38:39], v225 offset:63488
  v_mfma_f32_16x16x32_bf16 v[4:7], v[52:55], v[152:155], v[4:7]
  buffer_load_dwordx4 v[200:203], v232, s[12:15], s78 offen offset:1024
  buffer_load_dwordx4 v[204:207], v232, s[12:15], s78 offen offset:3072
  v_mfma_f32_16x16x32_bf16 v[20:23], v[52:55], v[156:159], v[20:23]
  ds_read_b64_tr_b16 v[40:41], v226 offset:61440
  ds_read_b64_tr_b16 v[42:43], v226 offset:63488
  v_mfma_f32_16x16x32_bf16 v[8:11], v[56:59], v[152:155], v[8:11]
  ds_read_b64_tr_b16 v[44:45], v227 offset:61440
  ds_read_b64_tr_b16 v[46:47], v227 offset:63488
  v_mfma_f32_16x16x32_bf16 v[24:27], v[56:59], v[156:159], v[24:27]
  v_mfma_f32_16x16x32_bf16 v[12:15], v[60:63], v[152:155], v[12:15]
  v_mfma_f32_16x16x32_bf16 v[28:31], v[60:63], v[156:159], v[28:31]
  s_waitcnt vmcnt(10) lgkmcnt(8)
  v_mfma_f32_16x16x32_bf16 v[0:3], v[64:67], v[160:163], v[0:3]
  ds_read_b64_tr_b16 v[48:49], v224 offset:0
  ds_read_b64_tr_b16 v[50:51], v224 offset:2048
  v_mfma_f32_16x16x32_bf16 v[16:19], v[64:67], v[164:167], v[16:19]
  ds_read_b64_tr_b16 v[52:53], v225 offset:0
  ds_read_b64_tr_b16 v[54:55], v225 offset:2048
  v_mfma_f32_16x16x32_bf16 v[4:7], v[68:71], v[160:163], v[4:7]
  s_add_u32 s78, s88, 196608
  buffer_load_dwordx4 v[208:211], v232, s[12:15], s78 offen offset:0
  v_mfma_f32_16x16x32_bf16 v[20:23], v[68:71], v[164:167], v[20:23]
  buffer_load_dwordx4 v[212:215], v232, s[12:15], s78 offen offset:2048
  ds_read_b64_tr_b16 v[56:57], v226 offset:0
  v_mfma_f32_16x16x32_bf16 v[8:11], v[72:75], v[160:163], v[8:11]
  ds_read_b64_tr_b16 v[58:59], v226 offset:2048
  ds_read_b64_tr_b16 v[60:61], v227 offset:0
  v_mfma_f32_16x16x32_bf16 v[24:27], v[72:75], v[164:167], v[24:27]
  ds_read_b64_tr_b16 v[62:63], v227 offset:2048
  v_mfma_f32_16x16x32_bf16 v[12:15], v[76:79], v[160:163], v[12:15]
  v_mfma_f32_16x16x32_bf16 v[28:31], v[76:79], v[164:167], v[28:31]
  s_waitcnt vmcnt(10) lgkmcnt(8)
  v_mfma_f32_16x16x32_bf16 v[0:3], v[32:35], v[168:171], v[0:3]
  ds_read_b64_tr_b16 v[64:65], v224 offset:4096
  ds_read_b64_tr_b16 v[66:67], v224 offset:6144
  v_mfma_f32_16x16x32_bf16 v[16:19], v[32:35], v[172:175], v[16:19]
  ds_read_b64_tr_b16 v[68:69], v225 offset:4096
  ds_read_b64_tr_b16 v[70:71], v225 offset:6144
  v_mfma_f32_16x16x32_bf16 v[4:7], v[36:39], v[168:171], v[4:7]
  buffer_load_dwordx4 v[216:219], v232, s[12:15], s78 offen offset:1024
  buffer_load_dwordx4 v[220:223], v232, s[12:15], s78 offen offset:3072
  v_mfma_f32_16x16x32_bf16 v[20:23], v[36:39], v[172:175], v[20:23]
  ds_read_b64_tr_b16 v[72:73], v226 offset:4096
  ds_read_b64_tr_b16 v[74:75], v226 offset:6144
  v_mfma_f32_16x16x32_bf16 v[8:11], v[40:43], v[168:171], v[8:11]
  ds_read_b64_tr_b16 v[76:77], v227 offset:4096
  ds_read_b64_tr_b16 v[78:79], v227 offset:6144
  v_mfma_f32_16x16x32_bf16 v[24:27], v[40:43], v[172:175], v[24:27]
  v_mfma_f32_16x16x32_bf16 v[12:15], v[44:47], v[168:171], v[12:15]
  v_mfma_f32_16x16x32_bf16 v[28:31], v[44:47], v[172:175], v[28:31]
  s_waitcnt vmcnt(10) lgkmcnt(8)
  v_mfma_f32_16x16x32_bf16 v[0:3], v[48:51], v[176:179], v[0:3]
  ds_read_b64_tr_b16 v[32:33], v224 offset:16384
  ds_read_b64_tr_b16 v[34:35], v224 offset:18432
  v_mfma_f32_16x16x32_bf16 v[16:19], v[48:51], v[180:183], v[16:19]
  ds_read_b64_tr_b16 v[36:37], v225 offset:16384
  ds_read_b64_tr_b16 v[38:39], v225 offset:18432
  v_mfma_f32_16x16x32_bf16 v[4:7], v[52:55], v[176:179], v[4:7]
  s_add_u32 s78, s88, 229376
  buffer_load_dwordx4 v[96:99], v232, s[12:15], s78 offen offset:0
  v_mfma_f32_16x16x32_bf16 v[20:23], v[52:55], v[180:183], v[20:23]
  buffer_load_dwordx4 v[100:103], v232, s[12:15], s78 offen offset:2048
  ds_read_b64_tr_b16 v[40:41], v226 offset:16384
  v_mfma_f32_16x16x32_bf16 v[8:11], v[56:59], v[176:179], v[8:11]
  ds_read_b64_tr_b16 v[42:43], v226 offset:18432
  ds_read_b64_tr_b16 v[44:45], v227 offset:16384
  v_mfma_f32_16x16x32_bf16 v[24:27], v[56:59], v[180:183], v[24:27]
  ds_read_b64_tr_b16 v[46:47], v227 offset:18432
  v_mfma_f32_16x16x32_bf16 v[12:15], v[60:63], v[176:179], v[12:15]
  v_mfma_f32_16x16x32_bf16 v[28:31], v[60:63], v[180:183], v[28:31]
  s_waitcnt vmcnt(10) lgkmcnt(8)
  v_mfma_f32_16x16x32_bf16 v[0:3], v[64:67], v[184:187], v[0:3]
  ds_read_b64_tr_b16 v[48:49], v224 offset:20480
  ds_read_b64_tr_b16 v[50:51], v224 offset:22528
  v_mfma_f32_16x16x32_bf16 v[16:19], v[64:67], v[188:191], v[16:19]
  ds_read_b64_tr_b16 v[52:53], v225 offset:20480
  ds_read_b64_tr_b16 v[54:55], v225 offset:22528
  v_mfma_f32_16x16x32_bf16 v[4:7], v[68:71], v[184:187], v[4:7]
  buffer_load_dwordx4 v[104:107], v232, s[12:15], s78 offen offset:1024
  buffer_load_dwordx4 v[108:111], v232, s[12:15], s78 offen offset:3072
  v_mfma_f32_16x16x32_bf16 v[20:23], v[68:71], v[188:191], v[20:23]
  ds_read_b64_tr_b16 v[56:57], v226 offset:20480
  ds_read_b64_tr_b16 v[58:59], v226 offset:22528
  v_mfma_f32_16x16x32_bf16 v[8:11], v[72:75], v[184:187], v[8:11]
  ds_read_b64_tr_b16 v[60:61], v227 offset:20480
  ds_read_b64_tr_b16 v[62:63], v227 offset:22528
  v_mfma_f32_16x16x32_bf16 v[24:27], v[72:75], v[188:191], v[24:27]
  v_mfma_f32_16x16x32_bf16 v[12:15], v[76:79], v[184:187], v[12:15]
  v_mfma_f32_16x16x32_bf16 v[28:31], v[76:79], v[188:191], v[28:31]
  s_waitcnt vmcnt(10) lgkmcnt(8)
  v_mfma_f32_16x16x32_bf16 v[0:3], v[32:35], v[192:195], v[0:3]
  ds_read_b64_tr_b16 v[64:65], v228 offset:32768
  ds_read_b64_tr_b16 v[66:67], v228 offset:34816
  v_mfma_f32_16x16x32_bf16 v[16:19], v[32:35], v[196:199], v[16:19]
  ds_read_b64_tr_b16 v[68:69], v229 offset:32768
  ds_read_b64_tr_b16 v[70:71], v229 offset:34816
  v_mfma_f32_16x16x32_bf16 v[4:7], v[36:39], v[192:195], v[4:7]
  s_add_u32 s78, s88, 81920
  buffer_load_dwordx4 v[112:115], v232, s[12:15], s78 offen offset:0
  v_mfma_f32_16x16x32_bf16 v[20:23], v[36:39], v[196:199], v[20:23]
  buffer_load_dwordx4 v[116:119], v232, s[12:15], s78 offen offset:2048
  ds_read_b64_tr_b16 v[72:73], v230 offset:32768
  v_mfma_f32_16x16x32_bf16 v[8:11], v[40:43], v[192:195], v[8:11]
  ds_read_b64_tr_b16 v[74:75], v230 offset:34816
  ds_read_b64_tr_b16 v[76:77], v231 offset:32768
  v_mfma_f32_16x16x32_bf16 v[24:27], v[40:43], v[196:199], v[24:27]
  ds_read_b64_tr_b16 v[78:79], v231 offset:34816
  v_mfma_f32_16x16x32_bf16 v[12:15], v[44:47], v[192:195], v[12:15]
  v_mfma_f32_16x16x32_bf16 v[28:31], v[44:47], v[196:199], v[28:31]
  s_waitcnt vmcnt(10) lgkmcnt(8)
  v_mfma_f32_16x16x32_bf16 v[0:3], v[48:51], v[200:203], v[0:3]
  ds_read_b64_tr_b16 v[32:33], v228 offset:36864
  ds_read_b64_tr_b16 v[34:35], v228 offset:38912
  v_mfma_f32_16x16x32_bf16 v[16:19], v[48:51], v[204:207], v[16:19]
  ds_read_b64_tr_b16 v[36:37], v229 offset:36864
  ds_read_b64_tr_b16 v[38:39], v229 offset:38912
  v_mfma_f32_16x16x32_bf16 v[4:7], v[52:55], v[200:203], v[4:7]
  buffer_load_dwordx4 v[120:123], v232, s[12:15], s78 offen offset:1024
  buffer_load_dwordx4 v[124:127], v232, s[12:15], s78 offen offset:3072
  v_mfma_f32_16x16x32_bf16 v[20:23], v[52:55], v[204:207], v[20:23]
  ds_read_b64_tr_b16 v[40:41], v230 offset:36864
  ds_read_b64_tr_b16 v[42:43], v230 offset:38912
  v_mfma_f32_16x16x32_bf16 v[8:11], v[56:59], v[200:203], v[8:11]
  ds_read_b64_tr_b16 v[44:45], v231 offset:36864
  ds_read_b64_tr_b16 v[46:47], v231 offset:38912
  v_mfma_f32_16x16x32_bf16 v[24:27], v[56:59], v[204:207], v[24:27]
  v_mfma_f32_16x16x32_bf16 v[12:15], v[60:63], v[200:203], v[12:15]
  v_mfma_f32_16x16x32_bf16 v[28:31], v[60:63], v[204:207], v[28:31]
  s_waitcnt vmcnt(10) lgkmcnt(8)
  v_mfma_f32_16x16x32_bf16 v[0:3], v[64:67], v[208:211], v[0:3]
  ds_read_b64_tr_b16 v[48:49], v228 offset:49152
  ds_read_b64_tr_b16 v[50:51], v228 offset:51200
  v_mfma_f32_16x16x32_bf16 v[16:19], v[64:67], v[212:215], v[16:19]
  ds_read_b64_tr_b16 v[52:53], v229 offset:49152
  ds_read_b64_tr_b16 v[54:55], v229 offset:51200
  v_mfma_f32_16x16x32_bf16 v[4:7], v[68:71], v[208:211], v[4:7]
  s_add_u32 s78, s88, 147456
  buffer_load_dwordx4 v[128:131], v232, s[12:15], s78 offen offset:0
  v_mfma_f32_16x16x32_bf16 v[20:23], v[68:71], v[212:215], v[20:23]
  buffer_load_dwordx4 v[132:135], v232, s[12:15], s78 offen offset:2048
  ds_read_b64_tr_b16 v[56:57], v230 offset:49152
  v_mfma_f32_16x16x32_bf16 v[8:11], v[72:75], v[208:211], v[8:11]
  ds_read_b64_tr_b16 v[58:59], v230 offset:51200
  ds_read_b64_tr_b16 v[60:61], v231 offset:49152
  v_mfma_f32_16x16x32_bf16 v[24:27], v[72:75], v[212:215], v[24:27]
  ds_read_b64_tr_b16 v[62:63], v231 offset:51200
  v_mfma_f32_16x16x32_bf16 v[12:15], v[76:79], v[208:211], v[12:15]
  v_mfma_f32_16x16x32_bf16 v[28:31], v[76:79], v[212:215], v[28:31]
  s_waitcnt vmcnt(10) lgkmcnt(8)
  v_mfma_f32_16x16x32_bf16 v[0:3], v[32:35], v[216:219], v[0:3]
  ds_read_b64_tr_b16 v[64:65], v228 offset:53248
  ds_read_b64_tr_b16 v[66:67], v228 offset:55296
  v_mfma_f32_16x16x32_bf16 v[16:19], v[32:35], v[220:223], v[16:19]
  ds_read_b64_tr_b16 v[68:69], v229 offset:53248
  ds_read_b64_tr_b16 v[70:71], v229 offset:55296
  v_mfma_f32_16x16x32_bf16 v[4:7], v[36:39], v[216:219], v[4:7]
  buffer_load_dwordx4 v[136:139], v232, s[12:15], s78 offen offset:1024
  buffer_load_dwordx4 v[140:143], v232, s[12:15], s78 offen offset:3072
  v_mfma_f32_16x16x32_bf16 v[20:23], v[36:39], v[220:223], v[20:23]
  ds_read_b64_tr_b16 v[72:73], v230 offset:53248
  ds_read_b64_tr_b16 v[74:75], v230 offset:55296
  v_mfma_f32_16x16x32_bf16 v[8:11], v[40:43], v[216:219], v[8:11]
  ds_read_b64_tr_b16 v[76:77], v231 offset:53248
  ds_read_b64_tr_b16 v[78:79], v231 offset:55296
  v_mfma_f32_16x16x32_bf16 v[24:27], v[40:43], v[220:223], v[24:27]
  v_mfma_f32_16x16x32_bf16 v[12:15], v[44:47], v[216:219], v[12:15]
  v_mfma_f32_16x16x32_bf16 v[28:31], v[44:47], v[220:223], v[28:31]
  s_waitcnt vmcnt(10) lgkmcnt(8)
  v_mfma_f32_16x16x32_bf16 v[0:3], v[48:51], v[96:99], v[0:3]
  ds_read_b64_tr_b16 v[32:33], v224 offset:40960
  ds_read_b64_tr_b16 v[34:35], v224 offset:43008
  v_mfma_f32_16x16x32_bf16 v[16:19], v[48:51], v[100:103], v[16:19]
  ds_read_b64_tr_b16 v[36:37], v225 offset:40960
  ds_read_b64_tr_b16 v[38:39], v225 offset:43008
  v_mfma_f32_16x16x32_bf16 v[4:7], v[52:55], v[96:99], v[4:7]
  s_add_u32 s78, s88, 245760
  buffer_load_dwordx4 v[144:147], v232, s[12:15], s78 offen offset:0
  v_mfma_f32_16x16x32_bf16 v[20:23], v[52:55], v[100:103], v[20:23]
  buffer_load_dwordx4 v[148:151], v232, s[12:15], s78 offen offset:2048
  ds_read_b64_tr_b16 v[40:41], v226 offset:40960
  v_mfma_f32_16x16x32_bf16 v[8:11], v[56:59], v[96:99], v[8:11]
  ds_read_b64_tr_b16 v[42:43], v226 offset:43008
  ds_read_b64_tr_b16 v[44:45], v227 offset:40960
  v_mfma_f32_16x16x32_bf16 v[24:27], v[56:59], v[100:103], v[24:27]
  ds_read_b64_tr_b16 v[46:47], v227 offset:43008
  v_mfma_f32_16x16x32_bf16 v[12:15], v[60:63], v[96:99], v[12:15]
  v_mfma_f32_16x16x32_bf16 v[28:31], v[60:63], v[100:103], v[28:31]
  s_waitcnt vmcnt(10) lgkmcnt(8)
  v_mfma_f32_16x16x32_bf16 v[0:3], v[64:67], v[104:107], v[0:3]
  ds_read_b64_tr_b16 v[48:49], v224 offset:45056
  ds_read_b64_tr_b16 v[50:51], v224 offset:47104
  v_mfma_f32_16x16x32_bf16 v[16:19], v[64:67], v[108:111], v[16:19]
  ds_read_b64_tr_b16 v[52:53], v225 offset:45056
  ds_read_b64_tr_b16 v[54:55], v225 offset:47104
  v_mfma_f32_16x16x32_bf16 v[4:7], v[68:71], v[104:107], v[4:7]
  buffer_load_dwordx4 v[152:155], v232, s[12:15], s78 offen offset:1024
  buffer_load_dwordx4 v[156:159], v232, s[12:15], s78 offen offset:3072
  v_mfma_f32_16x16x32_bf16 v[20:23], v[68:71], v[108:111], v[20:23]
  ds_read_b64_tr_b16 v[56:57], v226 offset:45056
  ds_read_b64_tr_b16 v[58:59], v226 offset:47104
  v_mfma_f32_16x16x32_bf16 v[8:11], v[72:75], v[104:107], v[8:11]
  ds_read_b64_tr_b16 v[60:61], v227 offset:45056
  ds_read_b64_tr_b16 v[62:63], v227 offset:47104
  v_mfma_f32_16x16x32_bf16 v[24:27], v[72:75], v[108:111], v[24:27]
  v_mfma_f32_16x16x32_bf16 v[12:15], v[76:79], v[104:107], v[12:15]
  v_mfma_f32_16x16x32_bf16 v[28:31], v[76:79], v[108:111], v[28:31]
  s_waitcnt vmcnt(10) lgkmcnt(8)
  v_mfma_f32_16x16x32_bf16 v[0:3], v[32:35], v[112:115], v[0:3]
  ds_read_b64_tr_b16 v[64:65], v228 offset:8192
  ds_read_b64_tr_b16 v[66:67], v228 offset:10240
  v_mfma_f32_16x16x32_bf16 v[16:19], v[32:35], v[116:119], v[16:19]
  ds_read_b64_tr_b16 v[68:69], v229 offset:8192
  ds_read_b64_tr_b16 v[70:71], v229 offset:10240
  v_mfma_f32_16x16x32_bf16 v[4:7], v[36:39], v[112:115], v[4:7]
  s_add_u32 s78, s88, 212992
  buffer_load_dwordx4 v[160:163], v232, s[12:15], s78 offen offset:0
  v_mfma_f32_16x16x32_bf16 v[20:23], v[36:39], v[116:119], v[20:23]
  buffer_load_dwordx4 v[164:167], v232, s[12:15], s78 offen offset:2048
  ds_read_b64_tr_b16 v[72:73], v230 offset:8192
  v_mfma_f32_16x16x32_bf16 v[8:11], v[40:43], v[112:115], v[8:11]
  ds_read_b64_tr_b16 v[74:75], v230 offset:10240
  ds_read_b64_tr_b16 v[76:77], v231 offset:8192
  v_mfma_f32_16x16x32_bf16 v[24:27], v[40:43], v[116:119], v[24:27]
  ds_read_b64_tr_b16 v[78:79], v231 offset:10240
  v_mfma_f32_16x16x32_bf16 v[12:15], v[44:47], v[112:115], v[12:15]
  v_mfma_f32_16x16x32_bf16 v[28:31], v[44:47], v[116:119], v[28:31]
  s_waitcnt vmcnt(10) lgkmcnt(8)
  v_mfma_f32_16x16x32_bf16 v[0:3], v[48:51], v[120:123], v[0:3]
  ds_read_b64_tr_b16 v[32:33], v228 offset:12288
  ds_read_b64_tr_b16 v[34:35], v228 offset:14336
  v_mfma_f32_16x16x32_bf16 v[16:19], v[48:51], v[124:127], v[16:19]
  ds_read_b64_tr_b16 v[36:37], v229 offset:12288
  ds_read_b64_tr_b16 v[38:39], v229 offset:14336
  v_mfma_f32_16x16x32_bf16 v[4:7], v[52:55], v[120:123], v[4:7]
  buffer_load_dwordx4 v[168:171], v232, s[12:15], s78 offen offset:1024
  buffer_load_dwordx4 v[172:175], v232, s[12:15], s78 offen offset:3072
  v_mfma_f32_16x16x32_bf16 v[20:23], v[52:55], v[124:127], v[20:23]
  ds_read_b64_tr_b16 v[40:41], v230 offset:12288
  ds_read_b64_tr_b16 v[42:43], v230 offset:14336
  v_mfma_f32_16x16x32_bf16 v[8:11], v[56:59], v[120:123], v[8:11]
  ds_read_b64_tr_b16 v[44:45], v231 offset:12288
  ds_read_b64_tr_b16 v[46:47], v231 offset:14336
  v_mfma_f32_16x16x32_bf16 v[24:27], v[56:59], v[124:127], v[24:27]
  v_mfma_f32_16x16x32_bf16 v[12:15], v[60:63], v[120:123], v[12:15]
  v_mfma_f32_16x16x32_bf16 v[28:31], v[60:63], v[124:127], v[28:31]
  s_waitcnt vmcnt(10) lgkmcnt(8)
  v_mfma_f32_16x16x32_bf16 v[0:3], v[64:67], v[128:131], v[0:3]
  ds_read_b64_tr_b16 v[48:49], v228 offset:57344
  ds_read_b64_tr_b16 v[50:51], v228 offset:59392
  v_mfma_f32_16x16x32_bf16 v[16:19], v[64:67], v[132:135], v[16:19]
  ds_read_b64_tr_b16 v[52:53], v229 offset:57344
  ds_read_b64_tr_b16 v[54:55], v229 offset:59392
  v_mfma_f32_16x16x32_bf16 v[4:7], v[68:71], v[128:131], v[4:7]
  s_add_u32 s78, s88, 16384
  buffer_load_dwordx4 v[176:179], v232, s[12:15], s78 offen offset:0
  v_mfma_f32_16x16x32_bf16 v[20:23], v[68:71], v[132:135], v[20:23]
  buffer_load_dwordx4 v[180:183], v232, s[12:15], s78 offen offset:2048
  ds_read_b64_tr_b16 v[56:57], v230 offset:57344
  v_mfma_f32_16x16x32_bf16 v[8:11], v[72:75], v[128:131], v[8:11]
  ds_read_b64_tr_b16 v[58:59], v230 offset:59392
  ds_read_b64_tr_b16 v[60:61], v231 offset:57344
  v_mfma_f32_16x16x32_bf16 v[24:27], v[72:75], v[132:135], v[24:27]
  ds_read_b64_tr_b16 v[62:63], v231 offset:59392
  v_mfma_f32_16x16x32_bf16 v[12:15], v[76:79], v[128:131], v[12:15]
  v_mfma_f32_16x16x32_bf16 v[28:31], v[76:79], v[132:135], v[28:31]
  s_waitcnt vmcnt(10) lgkmcnt(8)
  v_mfma_f32_16x16x32_bf16 v[0:3], v[32:35], v[136:139], v[0:3]
  ds_read_b64_tr_b16 v[64:65], v228 offset:61440
  ds_read_b64_tr_b16 v[66:67], v228 offset:63488
  v_mfma_f32_16x16x32_bf16 v[16:19], v[32:35], v[140:143], v[16:19]
  ds_read_b64_tr_b16 v[68:69], v229 offset:61440
  ds_read_b64_tr_b16 v[70:71], v229 offset:63488
  v_mfma_f32_16x16x32_bf16 v[4:7], v[36:39], v[136:139], v[4:7]
  buffer_load_dwordx4 v[184:187], v232, s[12:15], s78 offen offset:1024
  buffer_load_dwordx4 v[188:191], v232, s[12:15], s78 offen offset:3072
  v_mfma_f32_16x16x32_bf16 v[20:23], v[36:39], v[140:143], v[20:23]
  ds_read_b64_tr_b16 v[72:73], v230 offset:61440
  ds_read_b64_tr_b16 v[74:75], v230 offset:63488
  v_mfma_f32_16x16x32_bf16 v[8:11], v[40:43], v[136:139], v[8:11]
  ds_read_b64_tr_b16 v[76:77], v231 offset:61440
  ds_read_b64_tr_b16 v[78:79], v231 offset:63488
  v_mfma_f32_16x16x32_bf16 v[24:27], v[40:43], v[140:143], v[24:27]
  v_mfma_f32_16x16x32_bf16 v[12:15], v[44:47], v[136:139], v[12:15]
  v_mfma_f32_16x16x32_bf16 v[28:31], v[44:47], v[140:143], v[28:31]
  s_waitcnt vmcnt(10) lgkmcnt(8)
  v_mfma_f32_16x16x32_bf16 v[0:3], v[48:51], v[144:147], v[0:3]
  ds_read_b64_tr_b16 v[32:33], v228 offset:40960
  ds_read_b64_tr_b16 v[34:35], v228 offset:43008
  v_mfma_f32_16x16x32_bf16 v[16:19], v[48:51], v[148:151], v[16:19]
  ds_read_b64_tr_b16 v[36:37], v229 offset:40960
  ds_read_b64_tr_b16 v[38:39], v229 offset:43008
  v_mfma_f32_16x16x32_bf16 v[4:7], v[52:55], v[144:147], v[4:7]
  s_add_u32 s78, s88, 180224
  buffer_load_dwordx4 v[192:195], v232, s[12:15], s78 offen offset:0
  v_mfma_f32_16x16x32_bf16 v[20:23], v[52:55], v[148:151], v[20:23]
  buffer_load_dwordx4 v[196:199], v232, s[12:15], s78 offen offset:2048
  ds_read_b64_tr_b16 v[40:41], v230 offset:40960
  v_mfma_f32_16x16x32_bf16 v[8:11], v[56:59], v[144:147], v[8:11]
  ds_read_b64_tr_b16 v[42:43], v230 offset:43008
  ds_read_b64_tr_b16 v[44:45], v231 offset:40960
  v_mfma_f32_16x16x32_bf16 v[24:27], v[56:59], v[148:151], v[24:27]
  ds_read_b64_tr_b16 v[46:47], v231 offset:43008
  v_mfma_f32_16x16x32_bf16 v[12:15], v[60:63], v[144:147], v[12:15]
  v_mfma_f32_16x16x32_bf16 v[28:31], v[60:63], v[148:151], v[28:31]
  s_waitcnt vmcnt(10) lgkmcnt(8)
  v_mfma_f32_16x16x32_bf16 v[0:3], v[64:67], v[152:155], v[0:3]
  ds_read_b64_tr_b16 v[48:49], v228 offset:45056
  ds_read_b64_tr_b16 v[50:51], v228 offset:47104
  v_mfma_f32_16x16x32_bf16 v[16:19], v[64:67], v[156:159], v[16:19]
  ds_read_b64_tr_b16 v[52:53], v229 offset:45056
  ds_read_b64_tr_b16 v[54:55], v229 offset:47104
  v_mfma_f32_16x16x32_bf16 v[4:7], v[68:71], v[152:155], v[4:7]
  buffer_load_dwordx4 v[200:203], v232, s[12:15], s78 offen offset:1024
  buffer_load_dwordx4 v[204:207], v232, s[12:15], s78 offen offset:3072
  v_mfma_f32_16x16x32_bf16 v[20:23], v[68:71], v[156:159], v[20:23]
  ds_read_b64_tr_b16 v[56:57], v230 offset:45056
  ds_read_b64_tr_b16 v[58:59], v230 offset:47104
  v_mfma_f32_16x16x32_bf16 v[8:11], v[72:75], v[152:155], v[8:11]
  ds_read_b64_tr_b16 v[60:61], v231 offset:45056
  ds_read_b64_tr_b16 v[62:63], v231 offset:47104
  v_mfma_f32_16x16x32_bf16 v[24:27], v[72:75], v[156:159], v[24:27]
  v_mfma_f32_16x16x32_bf16 v[12:15], v[76:79], v[152:155], v[12:15]
  v_mfma_f32_16x16x32_bf16 v[28:31], v[76:79], v[156:159], v[28:31]
  s_waitcnt vmcnt(10) lgkmcnt(8)
  v_mfma_f32_16x16x32_bf16 v[0:3], v[32:35], v[160:163], v[0:3]
  ds_read_b64_tr_b16 v[64:65], v224 offset:8192
  ds_read_b64_tr_b16 v[66:67], v224 offset:10240
  v_mfma_f32_16x16x32_bf16 v[16:19], v[32:35], v[164:167], v[16:19]
  ds_read_b64_tr_b16 v[68:69], v225 offset:8192
  ds_read_b64_tr_b16 v[70:71], v225 offset:10240
  v_mfma_f32_16x16x32_bf16 v[4:7], v[36:39], v[160:163], v[4:7]
  s_add_u32 s78, s88, 49152
  buffer_load_dwordx4 v[208:211], v232, s[12:15], s78 offen offset:0
  v_mfma_f32_16x16x32_bf16 v[20:23], v[36:39], v[164:167], v[20:23]
  buffer_load_dwordx4 v[212:215], v232, s[12:15], s78 offen offset:2048
  ds_read_b64_tr_b16 v[72:73], v226 offset:8192
  v_mfma_f32_16x16x32_bf16 v[8:11], v[40:43], v[160:163], v[8:11]
  ds_read_b64_tr_b16 v[74:75], v226 offset:10240
  ds_read_b64_tr_b16 v[76:77], v227 offset:8192
  v_mfma_f32_16x16x32_bf16 v[24:27], v[40:43], v[164:167], v[24:27]
  ds_read_b64_tr_b16 v[78:79], v227 offset:10240
  v_mfma_f32_16x16x32_bf16 v[12:15], v[44:47], v[160:163], v[12:15]
  v_mfma_f32_16x16x32_bf16 v[28:31], v[44:47], v[164:167], v[28:31]
  s_waitcnt vmcnt(10) lgkmcnt(8)
  v_mfma_f32_16x16x32_bf16 v[0:3], v[48:51], v[168:171], v[0:3]
  ds_read_b64_tr_b16 v[32:33], v224 offset:12288
  ds_read_b64_tr_b16 v[34:35], v224 offset:14336
  v_mfma_f32_16x16x32_bf16 v[16:19], v[48:51], v[172:175], v[16:19]
  ds_read_b64_tr_b16 v[36:37], v225 offset:12288
  ds_read_b64_tr_b16 v[38:39], v225 offset:14336
  v_mfma_f32_16x16x32_bf16 v[4:7], v[52:55], v[168:171], v[4:7]
  buffer_load_dwordx4 v[216:219], v232, s[12:15], s78 offen offset:1024
  buffer_load_dwordx4 v[220:223], v232, s[12:15], s78 offen offset:3072
  v_mfma_f32_16x16x32_bf16 v[20:23], v[52:55], v[172:175], v[20:23]
  ds_read_b64_tr_b16 v[40:41], v226 offset:12288
  ds_read_b64_tr_b16 v[42:43], v226 offset:14336
  v_mfma_f32_16x16x32_bf16 v[8:11], v[56:59], v[168:171], v[8:11]
  ds_read_b64_tr_b16 v[44:45], v227 offset:12288
  ds_read_b64_tr_b16 v[46:47], v227 offset:14336
  v_mfma_f32_16x16x32_bf16 v[24:27], v[56:59], v[172:175], v[24:27]
  v_mfma_f32_16x16x32_bf16 v[12:15], v[60:63], v[168:171], v[12:15]
  v_mfma_f32_16x16x32_bf16 v[28:31], v[60:63], v[172:175], v[28:31]
  s_waitcnt vmcnt(10) lgkmcnt(8)
  v_mfma_f32_16x16x32_bf16 v[0:3], v[64:67], v[176:179], v[0:3]
  ds_read_b64_tr_b16 v[48:49], v228 offset:24576
  ds_read_b64_tr_b16 v[50:51], v228 offset:26624
  v_mfma_f32_16x16x32_bf16 v[16:19], v[64:67], v[180:183], v[16:19]
  ds_read_b64_tr_b16 v[52:53], v229 offset:24576
  ds_read_b64_tr_b16 v[54:55], v229 offset:26624
  v_mfma_f32_16x16x32_bf16 v[4:7], v[68:71], v[176:179], v[4:7]
  ds_read_b64_tr_b16 v[56:57], v230 offset:24576
  ds_read_b64_tr_b16 v[58:59], v230 offset:26624
  v_mfma_f32_16x16x32_bf16 v[20:23], v[68:71], v[180:183], v[20:23]
  ds_read_b64_tr_b16 v[60:61], v231 offset:24576
  ds_read_b64_tr_b16 v[62:63], v231 offset:26624
  v_mfma_f32_16x16x32_bf16 v[8:11], v[72:75], v[176:179], v[8:11]
  v_mfma_f32_16x16x32_bf16 v[24:27], v[72:75], v[180:183], v[24:27]
  v_mfma_f32_16x16x32_bf16 v[12:15], v[76:79], v[176:179], v[12:15]
  v_mfma_f32_16x16x32_bf16 v[28:31], v[76:79], v[180:183], v[28:31]
  s_waitcnt vmcnt(8) lgkmcnt(8)
  v_mfma_f32_16x16x32_bf16 v[0:3], v[32:35], v[184:187], v[0:3]
  ds_read_b64_tr_b16 v[64:65], v228 offset:28672
  ds_read_b64_tr_b16 v[66:67], v228 offset:30720
  v_mfma_f32_16x16x32_bf16 v[16:19], v[32:35], v[188:191], v[16:19]
  ds_read_b64_tr_b16 v[68:69], v229 offset:28672
  ds_read_b64_tr_b16 v[70:71], v229 offset:30720
  v_mfma_f32_16x16x32_bf16 v[4:7], v[36:39], v[184:187], v[4:7]
  ds_read_b64_tr_b16 v[72:73], v230 offset:28672
  ds_read_b64_tr_b16 v[74:75], v230 offset:30720
  v_mfma_f32_16x16x32_bf16 v[20:23], v[36:39], v[188:191], v[20:23]
  ds_read_b64_tr_b16 v[76:77], v231 offset:28672
  ds_read_b64_tr_b16 v[78:79], v231 offset:30720
  v_mfma_f32_16x16x32_bf16 v[8:11], v[40:43], v[184:187], v[8:11]
  v_mfma_f32_16x16x32_bf16 v[24:27], v[40:43], v[188:191], v[24:27]
  v_mfma_f32_16x16x32_bf16 v[12:15], v[44:47], v[184:187], v[12:15]
  v_mfma_f32_16x16x32_bf16 v[28:31], v[44:47], v[188:191], v[28:31]
  s_waitcnt vmcnt(6) lgkmcnt(8)
  v_mfma_f32_16x16x32_bf16 v[0:3], v[48:51], v[192:195], v[0:3]
  ds_read_b64_tr_b16 v[32:33], v224 offset:24576
  ds_read_b64_tr_b16 v[34:35], v224 offset:26624
  v_mfma_f32_16x16x32_bf16 v[16:19], v[48:51], v[196:199], v[16:19]
  ds_read_b64_tr_b16 v[36:37], v225 offset:24576
  ds_read_b64_tr_b16 v[38:39], v225 offset:26624
  v_mfma_f32_16x16x32_bf16 v[4:7], v[52:55], v[192:195], v[4:7]
  ds_read_b64_tr_b16 v[40:41], v226 offset:24576
  ds_read_b64_tr_b16 v[42:43], v226 offset:26624
  v_mfma_f32_16x16x32_bf16 v[20:23], v[52:55], v[196:199], v[20:23]
  ds_read_b64_tr_b16 v[44:45], v227 offset:24576
  ds_read_b64_tr_b16 v[46:47], v227 offset:26624
  v_mfma_f32_16x16x32_bf16 v[8:11], v[56:59], v[192:195], v[8:11]
  v_mfma_f32_16x16x32_bf16 v[24:27], v[56:59], v[196:199], v[24:27]
  v_mfma_f32_16x16x32_bf16 v[12:15], v[60:63], v[192:195], v[12:15]
  v_mfma_f32_16x16x32_bf16 v[28:31], v[60:63], v[196:199], v[28:31]
  s_waitcnt vmcnt(4) lgkmcnt(8)
  v_mfma_f32_16x16x32_bf16 v[0:3], v[64:67], v[200:203], v[0:3]
  ds_read_b64_tr_b16 v[48:49], v224 offset:28672
  ds_read_b64_tr_b16 v[50:51], v224 offset:30720
  v_mfma_f32_16x16x32_bf16 v[16:19], v[64:67], v[204:207], v[16:19]
  ds_read_b64_tr_b16 v[52:53], v225 offset:28672
  ds_read_b64_tr_b16 v[54:55], v225 offset:30720
  v_mfma_f32_16x16x32_bf16 v[4:7], v[68:71], v[200:203], v[4:7]
  ds_read_b64_tr_b16 v[56:57], v226 offset:28672
  ds_read_b64_tr_b16 v[58:59], v226 offset:30720
  v_mfma_f32_16x16x32_bf16 v[20:23], v[68:71], v[204:207], v[20:23]
  ds_read_b64_tr_b16 v[60:61], v227 offset:28672
  ds_read_b64_tr_b16 v[62:63], v227 offset:30720
  v_mfma_f32_16x16x32_bf16 v[8:11], v[72:75], v[200:203], v[8:11]
  v_mfma_f32_16x16x32_bf16 v[24:27], v[72:75], v[204:207], v[24:27]
  v_mfma_f32_16x16x32_bf16 v[12:15], v[76:79], v[200:203], v[12:15]
  v_mfma_f32_16x16x32_bf16 v[28:31], v[76:79], v[204:207], v[28:31]
  s_waitcnt vmcnt(2) lgkmcnt(8)
  v_mfma_f32_16x16x32_bf16 v[0:3], v[32:35], v[208:211], v[0:3]
  v_mfma_f32_16x16x32_bf16 v[16:19], v[32:35], v[212:215], v[16:19]
  v_mfma_f32_16x16x32_bf16 v[4:7], v[36:39], v[208:211], v[4:7]
  v_mfma_f32_16x16x32_bf16 v[20:23], v[36:39], v[212:215], v[20:23]
  v_mfma_f32_16x16x32_bf16 v[8:11], v[40:43], v[208:211], v[8:11]
  v_mfma_f32_16x16x32_bf16 v[24:27], v[40:43], v[212:215], v[24:27]
  v_mfma_f32_16x16x32_bf16 v[12:15], v[44:47], v[208:211], v[12:15]
  v_mfma_f32_16x16x32_bf16 v[28:31], v[44:47], v[212:215], v[28:31]
  s_waitcnt vmcnt(0) lgkmcnt(0)
  v_mfma_f32_16x16x32_bf16 v[0:3], v[48:51], v[216:219], v[0:3]
  s_mov_b32 s60, 0xaaaaaaaa
  s_mov_b32 s61, 0xaaaaaaaa
  s_mov_b32 s62, 0xcccccccc
  v_mfma_f32_16x16x32_bf16 v[4:7], v[52:55], v[216:219], v[4:7]
  s_mov_b32 s63, 0xcccccccc
  s_add_u32 s58, s86, s87
  s_lshl_b32 s57, s54, 14
  v_mfma_f32_16x16x32_bf16 v[8:11], v[56:59], v[216:219], v[8:11]
  v_mfma_f32_16x16x32_bf16 v[12:15], v[60:63], v[216:219], v[12:15]
  v_mfma_f32_16x16x32_bf16 v[16:19], v[48:51], v[220:223], v[16:19]
  s_nop 1
  v_permlane16_swap_b32 v0, v4
  v_mfma_f32_16x16x32_bf16 v[20:23], v[52:55], v[220:223], v[20:23]
  v_permlane16_swap_b32_e64 v1, v5
  v_mfma_f32_16x16x32_bf16 v[24:27], v[56:59], v[220:223], v[24:27]
  v_permlane16_swap_b32_e64 v2, v6
  v_mfma_f32_16x16x32_bf16 v[28:31], v[60:63], v[220:223], v[28:31]
  v_permlane16_swap_b32_e64 v3, v7
  v_cvt_pk_bf16_f32 v80, v0, v1
  v_cvt_pk_bf16_f32 v81, v2, v3
  v_cvt_pk_bf16_f32 v82, v4, v5
  v_cvt_pk_bf16_f32 v83, v6, v7
  buffer_store_dwordx4 v[80:83], v234, s[24:27], 0 offen sc1
  v_permlane16_swap_b32_e64 v8, v12
  v_mfma_f32_16x16x32_bf16 v[100:103], v[80:83], v[80:83], 0
  v_permlane16_swap_b32_e64 v9, v13
  v_mfma_f32_16x16x32_bf16 v[96:99], v[248:251], v[80:83], 0
  v_permlane16_swap_b32 v10, v14
  v_permlane16_swap_b32 v11, v15
  v_cvt_pk_bf16_f32 v84, v8, v9
  v_cvt_pk_bf16_f32 v85, v10, v11
  v_cvt_pk_bf16_f32 v86, v12, v13
  v_cvt_pk_bf16_f32 v87, v14, v15
  buffer_store_dwordx4 v[84:87], v234, s[24:27], s87 offen sc1
  v_permlane16_swap_b32_e64 v16, v20
  v_mfma_f32_16x16x32_bf16 v[100:103], v[84:87], v[84:87], v[100:103]
  v_permlane16_swap_b32_e64 v17, v21
  v_mfma_f32_16x16x32_bf16 v[96:99], v[248:251], v[84:87], v[96:99]
  v_permlane16_swap_b32 v18, v22
  v_permlane16_swap_b32 v19, v23
  v_cvt_pk_bf16_f32 v88, v16, v17
  v_cvt_pk_bf16_f32 v89, v18, v19
  v_cvt_pk_bf16_f32 v90, v20, v21
  v_cvt_pk_bf16_f32 v91, v22, v23
  buffer_store_dwordx4 v[88:91], v234, s[24:27], s86 offen sc1
  v_permlane16_swap_b32_e64 v24, v28
  v_mfma_f32_16x16x32_bf16 v[108:111], v[88:91], v[88:91], 0
  v_permlane16_swap_b32_e64 v25, v29
  v_mfma_f32_16x16x32_bf16 v[104:107], v[248:251], v[88:91], 0
  v_permlane16_swap_b32 v26, v30
  v_permlane16_swap_b32 v27, v31
  v_cvt_pk_bf16_f32 v92, v24, v25
  v_cvt_pk_bf16_f32 v93, v26, v27
  v_cvt_pk_bf16_f32 v94, v28, v29
  v_cvt_pk_bf16_f32 v95, v30, v31
  buffer_store_dwordx4 v[92:95], v234, s[24:27], s58 offen sc1
  s_nop 0
  v_mfma_f32_16x16x32_bf16 v[108:111], v[92:95], v[92:95], v[108:111]
  v_mfma_f32_16x16x32_bf16 v[104:107], v[248:251], v[92:95], v[104:107]
  s_cmp_eq_u32 s50, 3
  s_cbranch_scc1 c_done
  v_cndmask_b32 v100, v100, v101, s[60:61]
  v_cndmask_b32 v102, v102, v103, s[60:61]
  v_cndmask_b32 v97, v100, v102, s[62:63]
  s_mov_b32 exec_lo, 0x00f0000f
  s_mov_b32 exec_hi, 0xf0000f00
  buffer_store_dwordx2 v[96:97], v235, s[28:31], s57 offen sc1
  v_cndmask_b32 v108, v108, v109, s[60:61]
  v_cndmask_b32 v110, v110, v111, s[60:61]
  v_cndmask_b32 v105, v108, v110, s[62:63]
  buffer_store_dwordx2 v[104:105], v235, s[28:31], s57 offen offset:128 sc1
  s_mov_b64 exec, -1
  s_barrier
  s_lshl_b32 s57, s50, 1
  s_add_u32 s57, s57, 1
  s_lshl_b32 s57, s57, 4
  s_add_u32 s57, s57, s53
  s_mul_i32 s57, s57, 16384
  s_mul_i32 s58, s54, 1024
  s_add_u32 s59, s57, s58
  v_mov_b32_e64 v239, s93
  v_mov_b32 v236, 156292
  v_mov_b32 v237, 1
  v_mov_b32 v240, 0
  s_mov_b64 exec, 1
  s_waitcnt vmcnt(0)
  ds_add_rtn_u32 v238, v236, v237
  s_waitcnt lgkmcnt(0)
  v_readfirstlane_b32 s57, v238
  s_nop 3
  s_and_b32 s57, s57, 3
  s_cmp_eq_u32 s57, 3
  s_cbranch_scc0 sig_x_skip
  buffer_store_dword v239, v240, s[32:35], s59 offen sc1
sig_x_skip:
  s_mov_b64 exec, -1
  s_add_u32 s50, s50, 1
  s_xor_b32 s51, s51, 8
  s_xor_b32 s53, s53, 8
  s_branch c_layer
c_done:
  s_barrier
  s_endpgm
loader:
  s_sub_u32 s56, s55, 4
  s_lshl_b32 s70, s56, 12
  s_lshl_b32 s71, s56, 9
  s_add_u32 s71, s71, 16384
  s_mul_i32 s72, s56, 6144
  s_add_u32 s72, s72, 55296
  s_lshl_b32 s73, s56, 11
  s_add_u32 s73, s73, 8192
  s_cmp_eq_u32 s56, 0
  s_cselect_b32 s84, 0xffffff00, -1
  s_cselect_b32 s86, 1, 0
  s_mov_b32 s85, 128
  s_lshr_b32 s89, s51, 0
  s_and_b32 s89, s89, 7
  s_mul_i32 s89, s89, 1
  s_and_b32 s65, s52, 3
  s_mul_i32 s65, s65, 0
  s_add_u32 s89, s89, s65
  s_mov_b32 s79, s89
  s_lshr_b32 s89, s51, 0
  s_and_b32 s89, s89, 15
  s_mul_i32 s89, s89, 1
  v_lshrrev_b32 v1, 3, v247
  v_and_b32 v2, 7, v247
  v_mov_b32 v5, 1073741824
  v_lshrrev_b32 v7, 1, v1
  v_and_b32 v6, 1, v7
  s_mov_b32 s65, 6144
  v_mul_lo_u32 v8, v1, s65
  v_or_b32 v9, 0, v6
  v_lshlrev_b32 v9, 1, v9
  v_xor_b32_e64 v9, v9, v2
  v_lshl_add_u32 v9, v9, 4, v8
  s_mul_i32 s65, s56, 6
  s_add_u32 s65, s65, 0
  s_lshr_b32 s66, s65, 3
  s_and_b32 s65, s65, 7
  s_mul_i32 s65, s65, 49152
  s_lshl_b32 s66, s66, 11
  s_add_u32 s65, s65, s66
  s_lshl_b32 s66, s52, 7
  s_add_u32 s65, s65, s66
  v_add_u32 v15, s65, v9
  v_or_b32 v9, 2, v6
  v_lshlrev_b32 v9, 1, v9
  v_xor_b32 v9, v9, v2
  v_lshl_add_u32 v9, v9, 4, v8
  s_mul_i32 s65, s56, 6
  s_add_u32 s65, s65, 1
  s_lshr_b32 s66, s65, 3
  s_and_b32 s65, s65, 7
  s_mul_i32 s65, s65, 49152
  s_lshl_b32 s66, s66, 11
  s_add_u32 s65, s65, s66
  s_lshl_b32 s66, s52, 7
  s_add_u32 s65, s65, s66
  v_add_u32 v16, s65, v9
  v_or_b32 v9, 0, v6
  v_lshlrev_b32 v9, 1, v9
  v_xor_b32 v9, v9, v2
  v_lshl_add_u32 v9, v9, 4, v8
  s_mul_i32 s65, s56, 6
  s_add_u32 s65, s65, 2
  s_lshr_b32 s66, s65, 3
  s_and_b32 s65, s65, 7
  s_mul_i32 s65, s65, 49152
  s_lshl_b32 s66, s66, 11
  s_add_u32 s65, s65, s66
  s_lshl_b32 s66, s52, 7
  s_add_u32 s65, s65, s66
  v_add_u32 v17, s65, v9
  v_or_b32 v9, 2, v6
  v_lshlrev_b32 v9, 1, v9
  v_xor_b32 v9, v9, v2
  v_lshl_add_u32 v9, v9, 4, v8
  s_mul_i32 s65, s56, 6
  s_add_u32 s65, s65, 3
  s_lshr_b32 s66, s65, 3
  s_and_b32 s65, s65, 7
  s_mul_i32 s65, s65, 49152
  s_lshl_b32 s66, s66, 11
  s_add_u32 s65, s65, s66
  s_lshl_b32 s66, s52, 7
  s_add_u32 s65, s65, s66
  v_add_u32 v18, s65, v9
  v_or_b32 v9, 0, v6
  v_lshlrev_b32 v9, 1, v9
  v_xor_b32 v9, v9, v2
  v_lshl_add_u32 v9, v9, 4, v8
  s_mul_i32 s65, s56, 6
  s_add_u32 s65, s65, 4
  s_lshr_b32 s66, s65, 3
  s_and_b32 s65, s65, 7
  s_mul_i32 s65, s65, 49152
  s_lshl_b32 s66, s66, 11
  s_add_u32 s65, s65, s66
  s_lshl_b32 s66, s52, 7
  s_add_u32 s65, s65, s66
  v_add_u32 v19, s65, v9
  v_or_b32 v9, 2, v6
  v_lshlrev_b32 v9, 1, v9
  v_xor_b32 v9, v9, v2
  v_lshl_add_u32 v9, v9, 4, v8
  s_mul_i32 s65, s56, 6
  s_add_u32 s65, s65, 5
  s_lshr_b32 s66, s65, 3
  s_and_b32 s65, s65, 7
  s_mul_i32 s65, s65, 49152
  s_lshl_b32 s66, s66, 11
  s_add_u32 s65, s65, s66
  s_lshl_b32 s66, s52, 7
  s_add_u32 s65, s65, s66
  v_add_u32 v20, s65, v9
  s_lshl_b32 s64, s51, 7
  s_sub_u32 s64, s64, 16
  s_lshl_b32 s65, s56, 5
  s_add_u32 s65, s65, s64
  v_add_u32 v8, 0, v1
  v_add_u32 v8, s65, v8
  v_xor_b32 v9, 0, v7
  v_xor_b32 v9, v9, v2
  v_lshlrev_b32 v10, 4, v9
  v_lshl_add_u32 v10, v8, 11, v10
  v_ashrrev_i32 v3, 7, v8
  v_lshlrev_b32 v40, 18, v3
  v_bfe_u32 v3, v8, 4, 3
  v_lshl_add_u32 v40, v3, 11, v40
  v_lshrrev_b32_e64 v3, 2, v9
  v_lshl_add_u32 v40, v3, 10, v40
  v_and_b32_e64 v3, 15, v8
  v_lshl_add_u32 v40, v3, 6, v40
  v_and_b32_e64 v3, 3, v9
  v_lshl_add_u32 v40, v3, 4, v40
  v_cmp_gt_i32 vcc, 0, v8
  s_nop 1
  v_cndmask_b32 v10, v10, v5, vcc
  v_cndmask_b32 v40, v40, v5, vcc
  v_add_u32 v8, 8, v1
  v_add_u32 v8, s65, v8
  v_xor_b32 v9, 4, v7
  v_xor_b32 v9, v9, v2
  v_lshlrev_b32_e64 v11, 4, v9
  v_lshl_add_u32 v11, v8, 11, v11
  v_ashrrev_i32 v3, 7, v8
  v_lshlrev_b32 v41, 18, v3
  v_bfe_u32 v3, v8, 4, 3
  v_lshl_add_u32 v41, v3, 11, v41
  v_lshrrev_b32_e64 v3, 2, v9
  v_lshl_add_u32 v41, v3, 10, v41
  v_and_b32_e64 v3, 15, v8
  v_lshl_add_u32 v41, v3, 6, v41
  v_and_b32_e64 v3, 3, v9
  v_lshl_add_u32 v41, v3, 4, v41
  v_cmp_gt_i32 vcc, 0, v8
  s_nop 1
  v_cndmask_b32 v11, v11, v5, vcc
  v_cndmask_b32 v41, v41, v5, vcc
  v_add_u32 v8, 16, v1
  v_add_u32 v8, s65, v8
  v_xor_b32 v9, 0, v7
  v_xor_b32 v9, v9, v2
  v_lshlrev_b32_e64 v12, 4, v9
  v_lshl_add_u32 v12, v8, 11, v12
  v_ashrrev_i32 v3, 7, v8
  v_lshlrev_b32 v42, 18, v3
  v_bfe_u32 v3, v8, 4, 3
  v_lshl_add_u32 v42, v3, 11, v42
  v_lshrrev_b32_e64 v3, 2, v9
  v_lshl_add_u32 v42, v3, 10, v42
  v_and_b32_e64 v3, 15, v8
  v_lshl_add_u32 v42, v3, 6, v42
  v_and_b32_e64 v3, 3, v9
  v_lshl_add_u32 v42, v3, 4, v42
  v_cmp_gt_i32 vcc, 0, v8
  s_nop 1
  v_cndmask_b32 v12, v12, v5, vcc
  v_cndmask_b32 v42, v42, v5, vcc
  v_add_u32 v8, 24, v1
  v_add_u32 v8, s65, v8
  v_xor_b32 v9, 4, v7
  v_xor_b32 v9, v9, v2
  v_lshlrev_b32_e64 v13, 4, v9
  v_lshl_add_u32 v13, v8, 11, v13
  v_ashrrev_i32 v3, 7, v8
  v_lshlrev_b32 v43, 18, v3
  v_bfe_u32 v3, v8, 4, 3
  v_lshl_add_u32 v43, v3, 11, v43
  v_lshrrev_b32_e64 v3, 2, v9
  v_lshl_add_u32 v43, v3, 10, v43
  v_and_b32_e64 v3, 15, v8
  v_lshl_add_u32 v43, v3, 6, v43
  v_and_b32_e64 v3, 3, v9
  v_lshl_add_u32 v43, v3, 4, v43
  v_cmp_gt_i32 vcc, 0, v8
  s_nop 1
  v_cndmask_b32 v13, v13, v5, vcc
  v_cndmask_b32 v43, v43, v5, vcc
  s_lshl_b32 s65, s56, 2
  s_add_u32 s65, s65, s64
  s_add_u32 s65, s65, 128
  v_add_u32 v8, s65, v1
  s_lshl_b32 s65, s56, 1
  v_add_u32 v9, s65, v7
  v_and_b32 v9, 7, v9
  v_xor_b32 v9, v9, v2
  v_lshlrev_b32 v14, 4, v9
  v_lshl_add_u32 v14, v8, 11, v14
  v_ashrrev_i32 v3, 7, v8
  v_lshlrev_b32 v44, 18, v3
  v_bfe_u32 v3, v8, 4, 3
  v_lshl_add_u32 v44, v3, 11, v44
  v_lshrrev_b32_e64 v3, 2, v9
  v_lshl_add_u32 v44, v3, 10, v44
  v_and_b32_e64 v3, 15, v8
  v_lshl_add_u32 v44, v3, 6, v44
  v_and_b32_e64 v3, 3, v9
  v_lshl_add_u32 v44, v3, 4, v44
  s_mov_b32 s50, 0
  s_mov_b32 s74, 1
  s_lshl_b32 s57, s50, 22
  s_add_u32 s58, s36, s57
  s_addc_u32 s59, s37, 0
  s_cmp_eq_u32 s50, 0
  s_cselect_b32 s4, s38, s58
  s_cselect_b32 s5, s39, s59
  s_mov_b32 s57, 262144
  s_cselect_b32 s18, 16384, s57
  s_add_u32 s12, s58, 16777216
  s_addc_u32 s13, s59, 0
  s_add_u32 s58, s58, 4194304
  s_addc_u32 s59, s59, 0
  s_cmp_eq_u32 s50, 3
  s_cselect_b32 s24, s40, s58
  s_cselect_b32 s25, s41, s59
  s_lshl_b32 s57, s50, 18
  s_add_u32 s57, s57, 33554432
  s_add_u32 s16, s36, s57
  s_addc_u32 s17, s37, 0
  s_add_u32 s28, s16, 262144
  s_addc_u32 s29, s17, 0
  s_bitcmp1_b32 s50, 0
  s_cselect_b32 s8, s44, s42
  s_cselect_b32 s9, s45, s43
  s_cselect_b32 s20, s48, s46
  s_cselect_b32 s21, s49, s47
  s_add_u32 s87, s89, 0
  s_and_b32 s87, s87, 15
  s_mul_i32 s87, s85, s87
  s_add_u32 m0, s70, 0
  s_mov_b32 exec_lo, s84
  buffer_load_dwordx4 v10, s[4:7], s87 offen lds
  s_mov_b32 exec_lo, -1
  s_add_u32 m0, s70, 1024
  s_nop 0
  buffer_load_dwordx4 v11, s[4:7], s87 offen lds
  s_add_u32 m0, s70, 2048
  s_nop 0
  buffer_load_dwordx4 v12, s[4:7], s87 offen lds
  s_add_u32 m0, s70, 3072
  s_nop 0
  buffer_load_dwordx4 v13, s[4:7], s87 offen lds
  s_add_u32 m0, s71, 0
  s_mov_b32 exec_hi, 0
  buffer_load_dwordx4 v14, s[4:7], s87 offen lds
  s_mov_b32 exec_hi, -1
  s_add_u32 s88, s89, 0
  s_and_b32 s88, s88, 15
  s_mul_i32 s88, s88, 393216
  s_add_u32 m0, s72, 0
  s_nop 0
  buffer_load_dwordx4 v15, s[8:11], s88 offen lds
  s_add_u32 m0, s72, 1024
  s_nop 0
  buffer_load_dwordx4 v16, s[8:11], s88 offen lds
  s_add_u32 m0, s72, 2048
  s_nop 0
  buffer_load_dwordx4 v17, s[8:11], s88 offen lds
  s_add_u32 m0, s72, 3072
  s_nop 0
  buffer_load_dwordx4 v18, s[8:11], s88 offen lds
  s_add_u32 m0, s72, 4096
  s_nop 0
  buffer_load_dwordx4 v19, s[8:11], s88 offen lds
  s_add_u32 m0, s72, 5120
  s_nop 0
  buffer_load_dwordx4 v20, s[8:11], s88 offen lds
  s_add_u32 s87, s89, 1
  s_and_b32 s87, s87, 15
  s_mul_i32 s87, s85, s87
  s_add_u32 m0, s70, 18432
  s_mov_b32 exec_lo, s84
  buffer_load_dwordx4 v10, s[4:7], s87 offen lds
  s_mov_b32 exec_lo, -1
  s_add_u32 m0, s70, 19456
  s_nop 0
  buffer_load_dwordx4 v11, s[4:7], s87 offen lds
  s_add_u32 m0, s70, 20480
  s_nop 0
  buffer_load_dwordx4 v12, s[4:7], s87 offen lds
  s_add_u32 m0, s70, 21504
  s_nop 0
  buffer_load_dwordx4 v13, s[4:7], s87 offen lds
  s_add_u32 m0, s71, 18432
  s_mov_b32 exec_hi, 0
  buffer_load_dwordx4 v14, s[4:7], s87 offen lds
  s_mov_b32 exec_hi, -1
  s_add_u32 s88, s89, 1
  s_and_b32 s88, s88, 15
  s_mul_i32 s88, s88, 393216
  s_add_u32 m0, s72, 24576
  s_nop 0
  buffer_load_dwordx4 v15, s[8:11], s88 offen lds
  s_add_u32 m0, s72, 25600
  s_nop 0
  buffer_load_dwordx4 v16, s[8:11], s88 offen lds
  s_add_u32 m0, s72, 26624
  s_nop 0
  buffer_load_dwordx4 v17, s[8:11], s88 offen lds
  s_add_u32 m0, s72, 27648
  s_nop 0
  buffer_load_dwordx4 v18, s[8:11], s88 offen lds
  s_add_u32 m0, s72, 28672
  s_nop 0
  buffer_load_dwordx4 v19, s[8:11], s88 offen lds
  s_add_u32 m0, s72, 29696
  s_nop 0
  buffer_load_dwordx4 v20, s[8:11], s88 offen lds
  s_add_u32 s88, s89, 2
  s_and_b32 s88, s88, 15
  s_mul_i32 s88, s88, 393216
  s_add_u32 m0, s72, 49152
  s_nop 0
  buffer_load_dwordx4 v15, s[8:11], s88 offen lds
  s_add_u32 m0, s72, 50176
  s_nop 0
  buffer_load_dwordx4 v16, s[8:11], s88 offen lds
  s_add_u32 m0, s72, 51200
  s_nop 0
  buffer_load_dwordx4 v17, s[8:11], s88 offen lds
  s_add_u32 m0, s72, 52224
  s_nop 0
  buffer_load_dwordx4 v18, s[8:11], s88 offen lds
  s_add_u32 m0, s72, 53248
  s_nop 0
  buffer_load_dwordx4 v19, s[8:11], s88 offen lds
  s_add_u32 m0, s72, 54272
  s_nop 0
  buffer_load_dwordx4 v20, s[8:11], s88 offen lds
  v_lshrrev_b32 v1, 3, v247
  v_and_b32 v2, 7, v247
  v_mov_b32 v5, 1073741824
  v_lshrrev_b32 v7, 1, v1
  v_and_b32 v6, 1, v7
  v_and_b32 v9, 3, v7
  v_lshlrev_b32 v9, 1, v9
  v_xor_b32 v9, v9, v2
  v_lshlrev_b32 v9, 4, v9
  s_lshl_b32 s65, s56, 4
  s_add_u32 s65, s65, 0
  v_add_u32_e64 v8, s65, v1
  v_lshl_add_u32 v9, v8, 11, v9
  s_lshl_b32 s65, s54, 7
  v_add_u32 v25, s65, v9
  v_and_b32 v9, 3, v7
  v_lshlrev_b32 v9, 1, v9
  v_xor_b32 v9, v9, v2
  v_lshlrev_b32 v9, 4, v9
  s_lshl_b32 s65, s56, 4
  s_add_u32 s65, s65, 8
  v_add_u32_e64 v8, s65, v1
  v_lshl_add_u32 v9, v8, 11, v9
  s_lshl_b32 s65, s54, 7
  v_add_u32 v26, s65, v9
  v_and_b32_e64 v8, 15, v247
  v_mul_u32_u24 v8, 1024, v8
  s_mul_i32 s65, s53, 16384
  v_add_u32_e64 v29, s65, v8
  s_max_u32 s66, s51, 1
  s_sub_u32 s66, s66, 1
  s_mul_i32 s66, s66, 16384
  s_mul_i32 s65, s51, 16384
  v_add_u32 v28, s65, v8
  v_add_u32 v9, s66, v8
  v_cmp_le_u32 vcc, 16, v247
  s_nop 1
  v_cndmask_b32 v28, v28, v9, vcc
  s_mul_i32 s65, s56, 36
  v_add_u32 v8, s65, v247
  v_lshlrev_b32 v33, 2, v8
  v_add_u32 v33, 153600, v33
  s_lshl_b32 s64, s51, 7
  s_sub_u32 s64, s64, 16
  v_add_u32 v8, s64, v8
  v_lshlrev_b32 v32, 3, v8
  v_cmp_gt_i32 vcc, 0, v8
  s_nop 1
  v_cndmask_b32 v32, v32, v5, vcc
  v_cmp_le_u32 vcc, 36, v247
  s_nop 1
  v_cndmask_b32 v32, v32, v5, vcc
  v_lshlrev_b32 v34, 2, v247
  v_mov_b32 v5, 1073741824
  v_cmp_le_u32 vcc, 24, v247
  s_nop 1
  v_cndmask_b32 v8, 0, 1, vcc
  v_mul_u32_u24 v9, 24, v8
  v_sub_u32 v9, v247, v9
  v_lshrrev_b32 v3, 3, v9
  v_and_b32 v9, 7, v9
  v_lshl_add_u32 v9, v8, 6, v9
  s_and_b32 s65, s51, 7
  s_lshl_b32 s65, s65, 3
  s_lshl_b32 s66, s56, 7
  s_add_u32 s65, s65, s66
  v_add_u32_e64 v9, s65, v9
  s_mov_b32 s65, 6144
  v_mul_lo_u32 v9, v9, s65
  v_lshl_add_u32 v9, v3, 11, v9
  s_lshl_b32 s65, s52, 7
  v_add_u32 v35, s65, v9
  v_cmp_le_u32 vcc, 48, v247
  s_nop 1
  v_cndmask_b32 v35, v35, v5, vcc
  s_and_b32 s65, s54, 7
  s_lshl_b32 s65, s65, 8
  s_lshl_b32 s66, s56, 6
  s_add_u32 s65, s65, s66
  v_add_u32 v9, s65, v247
  v_lshlrev_b32 v9, 7, v9
  s_lshl_b32 s65, s53, 18
  v_add_u32 v36, s65, v9
  s_and_b32 s65, s53, 3
  s_lshl_b32 s65, s65, 8
  s_lshl_b32 s66, s56, 6
  s_add_u32 s65, s65, s66
  v_add_u32 v9, s65, v247
  v_lshlrev_b32 v9, 11, v9
  s_lshl_b32 s65, s54, 7
  v_add_u32 v37, s65, v9
  s_add_u32 s87, s89, 2
  s_and_b32 s87, s87, 15
  s_mul_i32 s87, s85, s87
  s_add_u32 m0, s70, 36864
  s_mov_b32 exec_lo, s84
  buffer_load_dwordx4 v10, s[4:7], s87 offen lds
  s_mov_b32 exec_lo, -1
  s_add_u32 m0, s70, 37888
  s_nop 0
  buffer_load_dwordx4 v11, s[4:7], s87 offen lds
  s_waitcnt vmcnt(19)
  s_barrier
  s_add_u32 m0, s70, 38912
  s_nop 0
  buffer_load_dwordx4 v12, s[4:7], s87 offen lds
  s_add_u32 m0, s70, 39936
  s_nop 0
  buffer_load_dwordx4 v13, s[4:7], s87 offen lds
  s_add_u32 m0, s71, 36864
  s_mov_b32 exec_hi, 0
  buffer_load_dwordx4 v14, s[4:7], s87 offen lds
  s_mov_b32 exec_hi, -1
  s_add_u32 s88, s89, 3
  s_and_b32 s88, s88, 15
  s_mul_i32 s88, s88, 393216
  s_add_u32 m0, s72, 73728
  s_nop 0
  buffer_load_dwordx4 v15, s[8:11], s88 offen lds
  s_add_u32 m0, s72, 74752
  s_nop 0
  buffer_load_dwordx4 v16, s[8:11], s88 offen lds
  s_add_u32 m0, s72, 75776
  s_nop 0
  buffer_load_dwordx4 v17, s[8:11], s88 offen lds
  s_add_u32 m0, s72, 76800
  s_nop 0
  buffer_load_dwordx4 v18, s[8:11], s88 offen lds
  s_waitcnt vmcnt(15)
  s_barrier
  s_branch l_t0
l_layer:
  s_barrier
  s_add_u32 s87, s89, 0
  s_and_b32 s87, s87, 15
  s_mul_i32 s87, s85, s87
  s_add_u32 m0, s70, 0
  s_mov_b32 exec_lo, s84
  buffer_load_dwordx4 v10, s[4:7], s87 offen lds
  s_mov_b32 exec_lo, -1
  s_add_u32 m0, s70, 1024
  s_nop 0
  buffer_load_dwordx4 v11, s[4:7], s87 offen lds
  s_add_u32 m0, s70, 2048
  s_nop 0
  buffer_load_dwordx4 v12, s[4:7], s87 offen lds
  s_add_u32 m0, s70, 3072
  s_nop 0
  buffer_load_dwordx4 v13, s[4:7], s87 offen lds
  s_add_u32 m0, s71, 0
  s_mov_b32 exec_hi, 0
  buffer_load_dwordx4 v14, s[4:7], s87 offen lds
  s_mov_b32 exec_hi, -1
  s_add_u32 s87, s89, 1
  s_and_b32 s87, s87, 15
  s_mul_i32 s87, s85, s87
  s_add_u32 m0, s70, 18432
  s_mov_b32 exec_lo, s84
  buffer_load_dwordx4 v10, s[4:7], s87 offen lds
  s_mov_b32 exec_lo, -1
  s_add_u32 m0, s70, 19456
  s_nop 0
  buffer_load_dwordx4 v11, s[4:7], s87 offen lds
  s_add_u32 m0, s70, 20480
  s_nop 0
  buffer_load_dwordx4 v12, s[4:7], s87 offen lds
  s_add_u32 m0, s70, 21504
  s_nop 0
  buffer_load_dwordx4 v13, s[4:7], s87 offen lds
  s_add_u32 m0, s71, 18432
  s_mov_b32 exec_hi, 0
  buffer_load_dwordx4 v14, s[4:7], s87 offen lds
  s_mov_b32 exec_hi, -1
  s_add_u32 s87, s89, 2
  s_and_b32 s87, s87, 15
  s_mul_i32 s87, s85, s87
  s_add_u32 m0, s70, 36864
  s_mov_b32 exec_lo, s84
  buffer_load_dwordx4 v10, s[4:7], s87 offen lds
  s_mov_b32 exec_lo, -1
  s_add_u32 m0, s70, 37888
  s_nop 0
  buffer_load_dwordx4 v11, s[4:7], s87 offen lds
  s_waitcnt vmcnt(7)
  s_barrier
  s_add_u32 m0, s70, 38912
  s_nop 0
  buffer_load_dwordx4 v12, s[4:7], s87 offen lds
  s_add_u32 m0, s70, 39936
  s_nop 0
  buffer_load_dwordx4 v13, s[4:7], s87 offen lds
  s_add_u32 m0, s71, 36864
  s_mov_b32 exec_hi, 0
  buffer_load_dwordx4 v14, s[4:7], s87 offen lds
  s_mov_b32 exec_hi, -1
  s_add_u32 s88, s89, 3
  s_and_b32 s88, s88, 15
  s_mul_i32 s88, s88, 393216
  s_add_u32 m0, s72, 73728
  s_nop 0
  buffer_load_dwordx4 v15, s[8:11], s88 offen lds
  s_add_u32 m0, s72, 74752
  s_nop 0
  buffer_load_dwordx4 v16, s[8:11], s88 offen lds
  s_add_u32 m0, s72, 75776
  s_nop 0
  buffer_load_dwordx4 v17, s[8:11], s88 offen lds
  s_add_u32 m0, s72, 76800
  s_nop 0
  buffer_load_dwordx4 v18, s[8:11], s88 offen lds
  s_waitcnt vmcnt(9)
  s_barrier
l_t0:
  s_cmp_lg_u32 s74, 0
  s_cbranch_scc1 l_noxl
  s_lshl_b32 s75, s50, 1
  s_sub_u32 s75, s75, 1
  s_mul_i32 s75, s75, 262144
  s_mov_b32 exec_hi, 0
  buffer_load_dword v39, v28, s[32:35], s75 offen sc1
  s_mov_b32 exec_hi, -1
l_noxl:
  s_add_u32 s87, s89, 3
  s_and_b32 s87, s87, 15
  s_mul_i32 s87, s85, s87
  s_add_u32 m0, s70, 0
  s_mov_b32 exec_lo, s84
  buffer_load_dwordx4 v10, s[4:7], s87 offen lds
  s_mov_b32 exec_lo, -1
  s_add_u32 m0, s70, 1024
  s_nop 0
  buffer_load_dwordx4 v11, s[4:7], s87 offen lds
  s_add_u32 m0, s70, 2048
  s_nop 0
  buffer_load_dwordx4 v12, s[4:7], s87 offen lds
  s_add_u32 m0, s70, 3072
  s_nop 0
  buffer_load_dwordx4 v13, s[4:7], s87 offen lds
  s_add_u32 m0, s71, 0
  s_mov_b32 exec_hi, 0
  buffer_load_dwordx4 v14, s[4:7], s87 offen lds
  s_mov_b32 exec_hi, -1
  s_add_u32 s88, s89, 3
  s_and_b32 s88, s88, 15
  s_mul_i32 s88, s88, 393216
  s_add_u32 m0, s72, 77824
  s_nop 0
  buffer_load_dwordx4 v19, s[8:11], s88 offen lds
  s_add_u32 m0, s72, 78848
  s_nop 0
  buffer_load_dwordx4 v20, s[8:11], s88 offen lds
  s_add_u32 s88, s89, 4
  s_and_b32 s88, s88, 15
  s_mul_i32 s88, s88, 393216
  s_add_u32 m0, s72, 0
  s_nop 0
  buffer_load_dwordx4 v15, s[8:11], s88 offen lds
  s_add_u32 m0, s72, 1024
  s_nop 0
  buffer_load_dwordx4 v16, s[8:11], s88 offen lds
  s_add_u32 m0, s72, 2048
  s_nop 0
  buffer_load_dwordx4 v17, s[8:11], s88 offen lds
  s_add_u32 m0, s72, 3072
  s_nop 0
  buffer_load_dwordx4 v18, s[8:11], s88 offen lds
  s_add_u32 m0, s72, 4096
  s_nop 0
  buffer_load_dwordx4 v19, s[8:11], s88 offen lds
  s_add_u32 m0, s72, 5120
  s_nop 0
  buffer_load_dwordx4 v20, s[8:11], s88 offen lds
  s_waitcnt vmcnt(17)
  s_barrier
  s_add_u32 s87, s89, 4
  s_and_b32 s87, s87, 15
  s_mul_i32 s87, s85, s87
  s_add_u32 m0, s70, 18432
  s_mov_b32 exec_lo, s84
  buffer_load_dwordx4 v10, s[4:7], s87 offen lds
  s_mov_b32 exec_lo, -1
  s_add_u32 m0, s70, 19456
  s_nop 0
  buffer_load_dwordx4 v11, s[4:7], s87 offen lds
  s_add_u32 m0, s70, 20480
  s_nop 0
  buffer_load_dwordx4 v12, s[4:7], s87 offen lds
  s_add_u32 m0, s70, 21504
  s_nop 0
  buffer_load_dwordx4 v13, s[4:7], s87 offen lds
  s_add_u32 m0, s71, 18432
  s_mov_b32 exec_hi, 0
  buffer_load_dwordx4 v14, s[4:7], s87 offen lds
  s_mov_b32 exec_hi, -1
  s_add_u32 s88, s89, 5
  s_and_b32 s88, s88, 15
  s_mul_i32 s88, s88, 393216
  s_add_u32 m0, s72, 24576
  s_nop 0
  buffer_load_dwordx4 v15, s[8:11], s88 offen lds
  s_add_u32 m0, s72, 25600
  s_nop 0
  buffer_load_dwordx4 v16, s[8:11], s88 offen lds
  s_add_u32 m0, s72, 26624
  s_nop 0
  buffer_load_dwordx4 v17, s[8:11], s88 offen lds
  s_add_u32 m0, s72, 27648
  s_nop 0
  buffer_load_dwordx4 v18, s[8:11], s88 offen lds
  s_add_u32 m0, s72, 28672
  s_nop 0
  buffer_load_dwordx4 v19, s[8:11], s88 offen lds
  s_add_u32 m0, s72, 29696
  s_nop 0
  buffer_load_dwordx4 v20, s[8:11], s88 offen lds
  s_waitcnt vmcnt(17)
  s_cmp_lg_u32 s74, 0
  s_cbranch_scc1 l_noxc
  s_mov_b32 s66, 0
  s_mov_b32 exec_hi, 0
l_xc:
  v_cmp_eq_u32 vcc, s93, v39
  s_nop 3
  s_cmp_eq_u32 vcc_lo, -1
  s_cbranch_scc1 l_xcok
  s_add_u32 s66, s66, 1
  s_cmp_lt_u32 s66, 65536
  s_cbranch_scc0 l_xcok
  buffer_load_dword v39, v28, s[32:35], s75 offen sc1
  s_waitcnt vmcnt(0)
  s_branch l_xc
l_xcok:
  s_mov_b32 exec_hi, -1
l_noxc:
  s_barrier
  s_add_u32 s87, s89, 5
  s_and_b32 s87, s87, 15
  s_mul_i32 s87, s85, s87
  s_add_u32 m0, s70, 36864
  s_mov_b32 exec_lo, s84
  buffer_load_dwordx4 v10, s[4:7], s87 offen lds
  s_mov_b32 exec_lo, -1
  s_add_u32 m0, s70, 37888
  s_nop 0
  buffer_load_dwordx4 v11, s[4:7], s87 offen lds
  s_add_u32 m0, s70, 38912
  s_nop 0
  buffer_load_dwordx4 v12, s[4:7], s87 offen lds
  s_add_u32 m0, s70, 39936
  s_nop 0
  buffer_load_dwordx4 v13, s[4:7], s87 offen lds
  s_add_u32 m0, s71, 36864
  s_mov_b32 exec_hi, 0
  buffer_load_dwordx4 v14, s[4:7], s87 offen lds
  s_mov_b32 exec_hi, -1
  s_add_u32 s88, s89, 6
  s_and_b32 s88, s88, 15
  s_mul_i32 s88, s88, 393216
  s_add_u32 m0, s72, 49152
  s_nop 0
  buffer_load_dwordx4 v15, s[8:11], s88 offen lds
  s_add_u32 m0, s72, 50176
  s_nop 0
  buffer_load_dwordx4 v16, s[8:11], s88 offen lds
  s_add_u32 m0, s72, 51200
  s_nop 0
  buffer_load_dwordx4 v17, s[8:11], s88 offen lds
  s_add_u32 m0, s72, 52224
  s_nop 0
  buffer_load_dwordx4 v18, s[8:11], s88 offen lds
  s_add_u32 m0, s72, 53248
  s_nop 0
  buffer_load_dwordx4 v19, s[8:11], s88 offen lds
  s_add_u32 m0, s72, 54272
  s_nop 0
  buffer_load_dwordx4 v20, s[8:11], s88 offen lds
  s_waitcnt vmcnt(17)
  s_barrier
  s_add_u32 s87, s89, 6
  s_and_b32 s87, s87, 15
  s_mul_i32 s87, s85, s87
  s_add_u32 m0, s70, 0
  s_mov_b32 exec_lo, s84
  buffer_load_dwordx4 v10, s[4:7], s87 offen lds
  s_mov_b32 exec_lo, -1
  s_add_u32 m0, s70, 1024
  s_nop 0
  buffer_load_dwordx4 v11, s[4:7], s87 offen lds
  s_add_u32 m0, s70, 2048
  s_nop 0
  buffer_load_dwordx4 v12, s[4:7], s87 offen lds
  s_add_u32 m0, s70, 3072
  s_nop 0
  buffer_load_dwordx4 v13, s[4:7], s87 offen lds
  s_add_u32 m0, s71, 0
  s_mov_b32 exec_hi, 0
  buffer_load_dwordx4 v14, s[4:7], s87 offen lds
  s_mov_b32 exec_hi, -1
  s_add_u32 s88, s89, 7
  s_and_b32 s88, s88, 15
  s_mul_i32 s88, s88, 393216
  s_add_u32 m0, s72, 73728
  s_nop 0
  buffer_load_dwordx4 v15, s[8:11], s88 offen lds
  s_add_u32 m0, s72, 74752
  s_nop 0
  buffer_load_dwordx4 v16, s[8:11], s88 offen lds
  s_add_u32 m0, s72, 75776
  s_nop 0
  buffer_load_dwordx4 v17, s[8:11], s88 offen lds
  s_add_u32 m0, s72, 76800
  s_nop 0
  buffer_load_dwordx4 v18, s[8:11], s88 offen lds
  s_add_u32 m0, s72, 77824
  s_nop 0
  buffer_load_dwordx4 v19, s[8:11], s88 offen lds
  s_add_u32 m0, s72, 78848
  s_nop 0
  buffer_load_dwordx4 v20, s[8:11], s88 offen lds
  s_waitcnt vmcnt(17)
  s_barrier
  s_add_u32 s87, s89, 7
  s_and_b32 s87, s87, 15
  s_mul_i32 s87, s85, s87
  s_add_u32 m0, s70, 18432
  s_mov_b32 exec_lo, s84
  buffer_load_dwordx4 v10, s[4:7], s87 offen lds
  s_mov_b32 exec_lo, -1
  s_add_u32 m0, s70, 19456
  s_nop 0
  buffer_load_dwordx4 v11, s[4:7], s87 offen lds
  s_add_u32 m0, s70, 20480
  s_nop 0
  buffer_load_dwordx4 v12, s[4:7], s87 offen lds
  s_add_u32 m0, s70, 21504
  s_nop 0
  buffer_load_dwordx4 v13, s[4:7], s87 offen lds
  s_add_u32 m0, s71, 18432
  s_mov_b32 exec_hi, 0
  buffer_load_dwordx4 v14, s[4:7], s87 offen lds
  s_mov_b32 exec_hi, -1
  s_add_u32 s88, s89, 8
  s_and_b32 s88, s88, 15
  s_mul_i32 s88, s88, 393216
  s_add_u32 m0, s72, 0
  s_nop 0
  buffer_load_dwordx4 v15, s[8:11], s88 offen lds
  s_add_u32 m0, s72, 1024
  s_nop 0
  buffer_load_dwordx4 v16, s[8:11], s88 offen lds
  s_add_u32 m0, s72, 2048
  s_nop 0
  buffer_load_dwordx4 v17, s[8:11], s88 offen lds
  s_add_u32 m0, s72, 3072
  s_nop 0
  buffer_load_dwordx4 v18, s[8:11], s88 offen lds
  s_add_u32 m0, s72, 4096
  s_nop 0
  buffer_load_dwordx4 v19, s[8:11], s88 offen lds
  s_add_u32 m0, s72, 5120
  s_nop 0
  buffer_load_dwordx4 v20, s[8:11], s88 offen lds
  s_waitcnt vmcnt(17)
  s_barrier
  s_add_u32 s87, s89, 8
  s_and_b32 s87, s87, 15
  s_mul_i32 s87, s85, s87
  s_add_u32 m0, s70, 36864
  s_mov_b32 exec_lo, s84
  buffer_load_dwordx4 v10, s[4:7], s87 offen lds
  s_mov_b32 exec_lo, -1
  s_add_u32 m0, s70, 37888
  s_nop 0
  buffer_load_dwordx4 v11, s[4:7], s87 offen lds
  s_add_u32 m0, s70, 38912
  s_nop 0
  buffer_load_dwordx4 v12, s[4:7], s87 offen lds
  s_add_u32 m0, s70, 39936
  s_nop 0
  buffer_load_dwordx4 v13, s[4:7], s87 offen lds
  s_add_u32 m0, s71, 36864
  s_mov_b32 exec_hi, 0
  buffer_load_dwordx4 v14, s[4:7], s87 offen lds
  s_mov_b32 exec_hi, -1
  s_add_u32 s88, s89, 9
  s_and_b32 s88, s88, 15
  s_mul_i32 s88, s88, 393216
  s_add_u32 m0, s72, 24576
  s_nop 0
  buffer_load_dwordx4 v15, s[8:11], s88 offen lds
  s_add_u32 m0, s72, 25600
  s_nop 0
  buffer_load_dwordx4 v16, s[8:11], s88 offen lds
  s_add_u32 m0, s72, 26624
  s_nop 0
  buffer_load_dwordx4 v17, s[8:11], s88 offen lds
  s_add_u32 m0, s72, 27648
  s_nop 0
  buffer_load_dwordx4 v18, s[8:11], s88 offen lds
  s_add_u32 m0, s72, 28672
  s_nop 0
  buffer_load_dwordx4 v19, s[8:11], s88 offen lds
  s_add_u32 m0, s72, 29696
  s_nop 0
  buffer_load_dwordx4 v20, s[8:11], s88 offen lds
  s_waitcnt vmcnt(17)
  s_barrier
  s_add_u32 s87, s89, 9
  s_and_b32 s87, s87, 15
  s_mul_i32 s87, s85, s87
  s_add_u32 m0, s70, 0
  s_mov_b32 exec_lo, s84
  buffer_load_dwordx4 v10, s[4:7], s87 offen lds
  s_mov_b32 exec_lo, -1
  s_add_u32 m0, s70, 1024
  s_nop 0
  buffer_load_dwordx4 v11, s[4:7], s87 offen lds
  s_add_u32 m0, s70, 2048
  s_nop 0
  buffer_load_dwordx4 v12, s[4:7], s87 offen lds
  s_add_u32 m0, s70, 3072
  s_nop 0
  buffer_load_dwordx4 v13, s[4:7], s87 offen lds
  s_add_u32 m0, s71, 0
  s_mov_b32 exec_hi, 0
  buffer_load_dwordx4 v14, s[4:7], s87 offen lds
  s_mov_b32 exec_hi, -1
  s_add_u32 s88, s89, 10
  s_and_b32 s88, s88, 15
  s_mul_i32 s88, s88, 393216
  s_add_u32 m0, s72, 49152
  s_nop 0
  buffer_load_dwordx4 v15, s[8:11], s88 offen lds
  s_add_u32 m0, s72, 50176
  s_nop 0
  buffer_load_dwordx4 v16, s[8:11], s88 offen lds
  s_add_u32 m0, s72, 51200
  s_nop 0
  buffer_load_dwordx4 v17, s[8:11], s88 offen lds
  s_add_u32 m0, s72, 52224
  s_nop 0
  buffer_load_dwordx4 v18, s[8:11], s88 offen lds
  s_add_u32 m0, s72, 53248
  s_nop 0
  buffer_load_dwordx4 v19, s[8:11], s88 offen lds
  s_add_u32 m0, s72, 54272
  s_nop 0
  buffer_load_dwordx4 v20, s[8:11], s88 offen lds
  s_waitcnt vmcnt(17)
  s_barrier
  s_add_u32 s87, s89, 10
  s_and_b32 s87, s87, 15
  s_mul_i32 s87, s85, s87
  s_add_u32 m0, s70, 18432
  s_mov_b32 exec_lo, s84
  buffer_load_dwordx4 v10, s[4:7], s87 offen lds
  s_mov_b32 exec_lo, -1
  s_add_u32 m0, s70, 19456
  s_nop 0
  buffer_load_dwordx4 v11, s[4:7], s87 offen lds
  s_add_u32 m0, s70, 20480
  s_nop 0
  buffer_load_dwordx4 v12, s[4:7], s87 offen lds
  s_add_u32 m0, s70, 21504
  s_nop 0
  buffer_load_dwordx4 v13, s[4:7], s87 offen lds
  s_add_u32 m0, s71, 18432
  s_mov_b32 exec_hi, 0
  buffer_load_dwordx4 v14, s[4:7], s87 offen lds
  s_mov_b32 exec_hi, -1
  s_add_u32 s88, s89, 11
  s_and_b32 s88, s88, 15
  s_mul_i32 s88, s88, 393216
  s_add_u32 m0, s72, 73728
  s_nop 0
  buffer_load_dwordx4 v15, s[8:11], s88 offen lds
  s_add_u32 m0, s72, 74752
  s_nop 0
  buffer_load_dwordx4 v16, s[8:11], s88 offen lds
  s_add_u32 m0, s72, 75776
  s_nop 0
  buffer_load_dwordx4 v17, s[8:11], s88 offen lds
  s_add_u32 m0, s72, 76800
  s_nop 0
  buffer_load_dwordx4 v18, s[8:11], s88 offen lds
  s_add_u32 m0, s72, 77824
  s_nop 0
  buffer_load_dwordx4 v19, s[8:11], s88 offen lds
  s_add_u32 m0, s72, 78848
  s_nop 0
  buffer_load_dwordx4 v20, s[8:11], s88 offen lds
  s_waitcnt vmcnt(17)
  s_barrier
  s_add_u32 s87, s89, 11
  s_and_b32 s87, s87, 15
  s_mul_i32 s87, s85, s87
  s_add_u32 m0, s70, 36864
  s_mov_b32 exec_lo, s84
  buffer_load_dwordx4 v10, s[4:7], s87 offen lds
  s_mov_b32 exec_lo, -1
  s_add_u32 m0, s70, 37888
  s_nop 0
  buffer_load_dwordx4 v11, s[4:7], s87 offen lds
  s_add_u32 m0, s70, 38912
  s_nop 0
  buffer_load_dwordx4 v12, s[4:7], s87 offen lds
  s_add_u32 m0, s70, 39936
  s_nop 0
  buffer_load_dwordx4 v13, s[4:7], s87 offen lds
  s_add_u32 m0, s71, 36864
  s_mov_b32 exec_hi, 0
  buffer_load_dwordx4 v14, s[4:7], s87 offen lds
  s_mov_b32 exec_hi, -1
  s_add_u32 s88, s89, 12
  s_and_b32 s88, s88, 15
  s_mul_i32 s88, s88, 393216
  s_add_u32 m0, s72, 0
  s_nop 0
  buffer_load_dwordx4 v15, s[8:11], s88 offen lds
  s_add_u32 m0, s72, 1024
  s_nop 0
  buffer_load_dwordx4 v16, s[8:11], s88 offen lds
  s_add_u32 m0, s72, 2048
  s_nop 0
  buffer_load_dwordx4 v17, s[8:11], s88 offen lds
  s_add_u32 m0, s72, 3072
  s_nop 0
  buffer_load_dwordx4 v18, s[8:11], s88 offen lds
  s_add_u32 m0, s72, 4096
  s_nop 0
  buffer_load_dwordx4 v19, s[8:11], s88 offen lds
  s_add_u32 m0, s72, 5120
  s_nop 0
  buffer_load_dwordx4 v20, s[8:11], s88 offen lds
  s_cmp_eq_u32 s86, 0
  s_cbranch_scc1 l_nodbg
  v_mov_b32 v50, 156304
  ds_read_b32 v30, v50
  s_mov_b32 s67, 2097152
  s_mov_b32 exec_hi, 0
  buffer_load_dword v31, v28, s[32:35], s67 offen sc1
  s_mov_b32 exec_hi, -1
  s_waitcnt lgkmcnt(0)
  v_readfirstlane_b32 s93, v30
l_nodbg:
  s_waitcnt vmcnt(17)
  s_barrier
  s_add_u32 s87, s89, 12
  s_and_b32 s87, s87, 15
  s_mul_i32 s87, s85, s87
  s_add_u32 m0, s70, 0
  s_mov_b32 exec_lo, s84
  buffer_load_dwordx4 v10, s[4:7], s87 offen lds
  s_mov_b32 exec_lo, -1
  s_add_u32 m0, s70, 1024
  s_nop 0
  buffer_load_dwordx4 v11, s[4:7], s87 offen lds
  s_add_u32 m0, s70, 2048
  s_nop 0
  buffer_load_dwordx4 v12, s[4:7], s87 offen lds
  s_add_u32 m0, s70, 3072
  s_nop 0
  buffer_load_dwordx4 v13, s[4:7], s87 offen lds
  s_add_u32 m0, s71, 0
  s_mov_b32 exec_hi, 0
  buffer_load_dwordx4 v14, s[4:7], s87 offen lds
  s_mov_b32 exec_hi, -1
  s_add_u32 s88, s89, 13
  s_and_b32 s88, s88, 15
  s_mul_i32 s88, s88, 393216
  s_add_u32 m0, s72, 24576
  s_nop 0
  buffer_load_dwordx4 v15, s[8:11], s88 offen lds
  s_add_u32 m0, s72, 25600
  s_nop 0
  buffer_load_dwordx4 v16, s[8:11], s88 offen lds
  s_add_u32 m0, s72, 26624
  s_nop 0
  buffer_load_dwordx4 v17, s[8:11], s88 offen lds
  s_add_u32 m0, s72, 27648
  s_nop 0
  buffer_load_dwordx4 v18, s[8:11], s88 offen lds
  s_add_u32 m0, s72, 28672
  s_nop 0
  buffer_load_dwordx4 v19, s[8:11], s88 offen lds
  s_add_u32 m0, s72, 29696
  s_nop 0
  buffer_load_dwordx4 v20, s[8:11], s88 offen lds
  s_waitcnt vmcnt(17)
  s_barrier
  s_add_u32 s87, s89, 13
  s_and_b32 s87, s87, 15
  s_mul_i32 s87, s85, s87
  s_add_u32 m0, s70, 18432
  s_mov_b32 exec_lo, s84
  buffer_load_dwordx4 v10, s[4:7], s87 offen lds
  s_mov_b32 exec_lo, -1
  s_add_u32 m0, s70, 19456
  s_nop 0
  buffer_load_dwordx4 v11, s[4:7], s87 offen lds
  s_add_u32 m0, s70, 20480
  s_nop 0
  buffer_load_dwordx4 v12, s[4:7], s87 offen lds
  s_add_u32 m0, s70, 21504
  s_nop 0
  buffer_load_dwordx4 v13, s[4:7], s87 offen lds
  s_add_u32 m0, s71, 18432
  s_mov_b32 exec_hi, 0
  buffer_load_dwordx4 v14, s[4:7], s87 offen lds
  s_mov_b32 exec_hi, -1
  s_add_u32 s88, s89, 14
  s_and_b32 s88, s88, 15
  s_mul_i32 s88, s88, 393216
  s_add_u32 m0, s72, 49152
  s_nop 0
  buffer_load_dwordx4 v15, s[8:11], s88 offen lds
  s_add_u32 m0, s72, 50176
  s_nop 0
  buffer_load_dwordx4 v16, s[8:11], s88 offen lds
  s_add_u32 m0, s72, 51200
  s_nop 0
  buffer_load_dwordx4 v17, s[8:11], s88 offen lds
  s_add_u32 m0, s72, 52224
  s_nop 0
  buffer_load_dwordx4 v18, s[8:11], s88 offen lds
  s_add_u32 m0, s72, 53248
  s_nop 0
  buffer_load_dwordx4 v19, s[8:11], s88 offen lds
  s_add_u32 m0, s72, 54272
  s_nop 0
  buffer_load_dwordx4 v20, s[8:11], s88 offen lds
  s_waitcnt vmcnt(17)
  s_barrier
  s_add_u32 s87, s89, 14
  s_and_b32 s87, s87, 15
  s_mul_i32 s87, s85, s87
  s_add_u32 m0, s70, 36864
  s_mov_b32 exec_lo, s84
  buffer_load_dwordx4 v10, s[4:7], s87 offen lds
  s_mov_b32 exec_lo, -1
  s_add_u32 m0, s70, 37888
  s_nop 0
  buffer_load_dwordx4 v11, s[4:7], s87 offen lds
  s_add_u32 m0, s70, 38912
  s_nop 0
  buffer_load_dwordx4 v12, s[4:7], s87 offen lds
  s_add_u32 m0, s70, 39936
  s_nop 0
  buffer_load_dwordx4 v13, s[4:7], s87 offen lds
  s_add_u32 m0, s71, 36864
  s_mov_b32 exec_hi, 0
  buffer_load_dwordx4 v14, s[4:7], s87 offen lds
  s_mov_b32 exec_hi, -1
  s_add_u32 s88, s89, 15
  s_and_b32 s88, s88, 15
  s_mul_i32 s88, s88, 393216
  s_add_u32 m0, s72, 73728
  s_nop 0
  buffer_load_dwordx4 v15, s[8:11], s88 offen lds
  s_add_u32 m0, s72, 74752
  s_nop 0
  buffer_load_dwordx4 v16, s[8:11], s88 offen lds
  s_add_u32 m0, s72, 75776
  s_nop 0
  buffer_load_dwordx4 v17, s[8:11], s88 offen lds
  s_add_u32 m0, s72, 76800
  s_nop 0
  buffer_load_dwordx4 v18, s[8:11], s88 offen lds
  s_add_u32 m0, s72, 77824
  s_nop 0
  buffer_load_dwordx4 v19, s[8:11], s88 offen lds
  s_add_u32 m0, s72, 78848
  s_nop 0
  buffer_load_dwordx4 v20, s[8:11], s88 offen lds
  s_waitcnt vmcnt(17)
  s_cmp_eq_u32 s86, 0
  s_cbranch_scc1 l_nochk
  s_mov_b32 s66, 0
  s_mov_b32 exec_hi, 0
l_chk:
  v_cmp_eq_u32_e64 vcc, s93, v31
  s_nop 3
  s_cmp_eq_u32 vcc_lo, -1
  s_cbranch_scc1 l_chkok
  s_add_u32 s66, s66, 1
  s_cmp_lt_u32 s66, 65536
  s_cbranch_scc0 l_chkok
  s_sleep 1
  buffer_load_dword v31, v28, s[32:35], s67 offen sc1
  s_waitcnt vmcnt(0)
  s_branch l_chk
l_chkok:
  s_mov_b32 exec_hi, -1
l_nochk:
  s_mov_b32 s86, 0
  s_barrier
  s_add_u32 s87, s89, 15
  s_and_b32 s87, s87, 15
  s_mul_i32 s87, s85, s87
  s_add_u32 m0, s70, 0
  s_mov_b32 exec_lo, s84
  buffer_load_dwordx4 v10, s[4:7], s87 offen lds
  s_mov_b32 exec_lo, -1
  s_add_u32 m0, s70, 1024
  s_nop 0
  buffer_load_dwordx4 v11, s[4:7], s87 offen lds
  s_add_u32 m0, s70, 2048
  s_nop 0
  buffer_load_dwordx4 v12, s[4:7], s87 offen lds
  s_add_u32 m0, s70, 3072
  s_nop 0
  buffer_load_dwordx4 v13, s[4:7], s87 offen lds
  s_add_u32 m0, s71, 0
  s_mov_b32 exec_hi, 0
  buffer_load_dwordx4 v14, s[4:7], s87 offen lds
  s_mov_b32 exec_hi, -1
  s_mov_b32 s57, 0
  buffer_load_dwordx2 v[64:65], v32, s[16:19], s57 offen
  s_mov_b32 s57, 16384
  buffer_load_dwordx2 v[66:67], v32, s[16:19], s57 offen
  s_mov_b32 s57, 32768
  buffer_load_dwordx2 v[68:69], v32, s[16:19], s57 offen
  s_mov_b32 s57, 49152
  buffer_load_dwordx2 v[70:71], v32, s[16:19], s57 offen
  s_mov_b32 s57, 65536
  buffer_load_dwordx2 v[72:73], v32, s[16:19], s57 offen
  s_mov_b32 s57, 81920
  buffer_load_dwordx2 v[74:75], v32, s[16:19], s57 offen
  s_mov_b32 s57, 98304
  buffer_load_dwordx2 v[76:77], v32, s[16:19], s57 offen
  s_mov_b32 s57, 114688
  buffer_load_dwordx2 v[78:79], v32, s[16:19], s57 offen
  s_waitcnt vmcnt(19)
  s_barrier
  s_mov_b32 s57, 131072
  buffer_load_dwordx2 v[80:81], v32, s[16:19], s57 offen
  s_mov_b32 s57, 147456
  buffer_load_dwordx2 v[82:83], v32, s[16:19], s57 offen
  s_mov_b32 s57, 163840
  buffer_load_dwordx2 v[84:85], v32, s[16:19], s57 offen
  s_mov_b32 s57, 180224
  buffer_load_dwordx2 v[86:87], v32, s[16:19], s57 offen
  s_mov_b32 s57, 196608
  buffer_load_dwordx2 v[88:89], v32, s[16:19], s57 offen
  s_mov_b32 s57, 212992
  buffer_load_dwordx2 v[90:91], v32, s[16:19], s57 offen
  s_mov_b32 s57, 229376
  buffer_load_dwordx2 v[92:93], v32, s[16:19], s57 offen
  s_mov_b32 s57, 245760
  buffer_load_dwordx2 v[94:95], v32, s[16:19], s57 offen
  s_waitcnt vmcnt(16)
  s_barrier
  s_waitcnt vmcnt(14)
  v_pk_add_f32 v[64:65], v[64:65], v[66:67]
  s_waitcnt vmcnt(13)
  v_pk_add_f32 v[64:65], v[64:65], v[68:69]
  s_waitcnt vmcnt(12)
  v_pk_add_f32 v[64:65], v[64:65], v[70:71]
  s_waitcnt vmcnt(11)
  v_pk_add_f32 v[64:65], v[64:65], v[72:73]
  s_waitcnt vmcnt(10)
  v_pk_add_f32 v[64:65], v[64:65], v[74:75]
  s_waitcnt vmcnt(9)
  v_pk_add_f32 v[64:65], v[64:65], v[76:77]
  s_waitcnt vmcnt(8)
  v_pk_add_f32 v[64:65], v[64:65], v[78:79]
  s_waitcnt vmcnt(7)
  v_pk_add_f32 v[64:65], v[64:65], v[80:81]
  s_waitcnt vmcnt(6)
  v_pk_add_f32 v[64:65], v[64:65], v[82:83]
  s_waitcnt vmcnt(5)
  v_pk_add_f32 v[64:65], v[64:65], v[84:85]
  s_waitcnt vmcnt(4)
  v_pk_add_f32 v[64:65], v[64:65], v[86:87]
  s_waitcnt vmcnt(3)
  v_pk_add_f32 v[64:65], v[64:65], v[88:89]
  s_waitcnt vmcnt(2)
  v_pk_add_f32 v[64:65], v[64:65], v[90:91]
  s_waitcnt vmcnt(1)
  v_pk_add_f32 v[64:65], v[64:65], v[92:93]
  s_waitcnt vmcnt(0)
  v_pk_add_f32 v[64:65], v[64:65], v[94:95]
  v_mul_f32 v64, 0x3a800000, v64
  v_mul_f32 v65, 0x3a800000, v65
  v_fma_f32 v65, -v64, v64, v65
  v_max_f32 v65, 0, v65
  v_add_f32 v65, 0x3727c5ac, v65
  v_rsq_f32 v65, v65
  v_sub_f32_e64 v64, 0, v64
  s_mov_b32 exec_hi, 0xf
  ds_write_b32 v33, v64
  ds_write_b32 v33, v65 offset:576
  s_mov_b32 exec_hi, -1
  s_waitcnt lgkmcnt(0)
  s_barrier
  s_mov_b32 s89, s79
  s_add_u32 m0, s73, 0
  s_mov_b32 s58, 0
  buffer_load_dwordx4 v25, s[20:23], s58 offen lds
  s_add_u32 m0, m0, 1024
  s_nop 0
  buffer_load_dwordx4 v26, s[20:23], s58 offen lds
  s_add_u32 m0, s73, 8192
  s_mov_b32 s58, 131072
  buffer_load_dwordx4 v25, s[20:23], s58 offen lds
  s_add_u32 m0, m0, 1024
  s_nop 0
  buffer_load_dwordx4 v26, s[20:23], s58 offen lds
  s_add_u32 m0, s73, 16384
  s_mov_b32 s58, 262144
  buffer_load_dwordx4 v25, s[20:23], s58 offen lds
  s_add_u32 m0, m0, 1024
  s_nop 0
  buffer_load_dwordx4 v26, s[20:23], s58 offen lds
  s_add_u32 m0, s73, 24576
  s_mov_b32 s58, 393216
  buffer_load_dwordx4 v25, s[20:23], s58 offen lds
  s_add_u32 m0, m0, 1024
  s_nop 0
  buffer_load_dwordx4 v26, s[20:23], s58 offen lds
  s_cmp_ge_u32 s50, 2
  s_cbranch_scc1 l_nocs
  s_barrier
l_nocs:
  s_add_u32 m0, s73, 32768
  s_mov_b32 s58, 524288
  buffer_load_dwordx4 v25, s[20:23], s58 offen lds
  s_add_u32 m0, m0, 1024
  s_nop 0
  buffer_load_dwordx4 v26, s[20:23], s58 offen lds
  s_add_u32 m0, s73, 40960
  s_mov_b32 s58, 655360
  buffer_load_dwordx4 v25, s[20:23], s58 offen lds
  s_add_u32 m0, m0, 1024
  s_nop 0
  buffer_load_dwordx4 v26, s[20:23], s58 offen lds
  s_barrier
  s_add_u32 m0, s73, 49152
  s_mov_b32 s58, 786432
  buffer_load_dwordx4 v25, s[20:23], s58 offen lds
  s_add_u32 m0, m0, 1024
  s_nop 0
  buffer_load_dwordx4 v26, s[20:23], s58 offen lds
  s_add_u32 m0, s73, 57344
  s_mov_b32 s58, 917504
  buffer_load_dwordx4 v25, s[20:23], s58 offen lds
  s_add_u32 m0, m0, 1024
  s_nop 0
  buffer_load_dwordx4 v26, s[20:23], s58 offen lds
  s_add_u32 m0, s73, 65536
  s_mov_b32 s58, 1048576
  buffer_load_dwordx4 v25, s[20:23], s58 offen lds
  s_add_u32 m0, m0, 1024
  s_nop 0
  buffer_load_dwordx4 v26, s[20:23], s58 offen lds
  s_add_u32 m0, s73, 73728
  s_mov_b32 s58, 1179648
  buffer_load_dwordx4 v25, s[20:23], s58 offen lds
  s_add_u32 m0, m0, 1024
  s_nop 0
  buffer_load_dwordx4 v26, s[20:23], s58 offen lds
  s_add_u32 m0, s73, 81920
  s_mov_b32 s58, 1310720
  buffer_load_dwordx4 v25, s[20:23], s58 offen lds
  s_add_u32 m0, m0, 1024
  s_nop 0
  buffer_load_dwordx4 v26, s[20:23], s58 offen lds
  s_add_u32 m0, s73, 90112
  s_mov_b32 s58, 1441792
  buffer_load_dwordx4 v25, s[20:23], s58 offen lds
  s_add_u32 m0, m0, 1024
  s_nop 0
  buffer_load_dwordx4 v26, s[20:23], s58 offen lds
  s_add_u32 m0, s73, 98304
  s_mov_b32 s58, 1572864
  buffer_load_dwordx4 v25, s[20:23], s58 offen lds
  s_add_u32 m0, m0, 1024
  s_nop 0
  buffer_load_dwordx4 v26, s[20:23], s58 offen lds
  s_add_u32 m0, s73, 106496
  s_mov_b32 s58, 1703936
  buffer_load_dwordx4 v25, s[20:23], s58 offen lds
  s_add_u32 m0, m0, 1024
  s_nop 0
  buffer_load_dwordx4 v26, s[20:23], s58 offen lds
  s_add_u32 m0, s73, 114688
  s_mov_b32 s58, 1835008
  buffer_load_dwordx4 v25, s[20:23], s58 offen lds
  s_add_u32 m0, m0, 1024
  s_nop 0
  buffer_load_dwordx4 v26, s[20:23], s58 offen lds
  s_add_u32 m0, s73, 122880
  s_mov_b32 s58, 1966080
  buffer_load_dwordx4 v25, s[20:23], s58 offen lds
  s_add_u32 m0, m0, 1024
  s_nop 0
  buffer_load_dwordx4 v26, s[20:23], s58 offen lds
  s_waitcnt vmcnt(0)
  s_cmp_lg_u32 s56, 0
  s_cbranch_scc1 l_noo
  s_mul_i32 s67, s50, 524288
  s_mov_b32 exec_hi, 0
  s_mov_b32 exec_lo, 0xffff
  s_mov_b32 s66, 0
poll_oa:
  buffer_load_dword v50, v29, s[32:35], s67 offen sc1
  s_waitcnt vmcnt(0)
  v_cmp_eq_u32_e64 vcc, s93, v50
  s_nop 3
  s_mov_b32 s65, vcc_lo
  s_and_b32 s64, s65, 0x550
  s_cmp_eq_u32 s64, 0x550
  s_cbranch_scc1 poll_oa_ok
  s_add_u32 s66, s66, 1
  s_cmp_lt_u32 s66, 65536
  s_cbranch_scc0 poll_oa_ok
  s_sleep 1
  s_branch poll_oa
poll_oa_ok:
  s_barrier
  s_cmp_eq_u32 s65, 0xffff
  s_cbranch_scc1 poll_ob_ok
  s_mov_b32 s66, 0
poll_ob:
  buffer_load_dword v50, v29, s[32:35], s67 offen sc1
  s_waitcnt vmcnt(0)
  v_cmp_eq_u32_e64 vcc, s93, v50
  s_nop 3
  s_cmp_eq_u32 vcc_lo, 0xffff
  s_cbranch_scc1 poll_ob_ok
  s_add_u32 s66, s66, 1
  s_cmp_lt_u32 s66, 65536
  s_cbranch_scc0 poll_ob_ok
  s_sleep 1
  s_branch poll_ob
poll_ob_ok:
  s_mov_b64 exec, -1
  s_branch l_x2
l_noo:
  s_barrier
l_x2:
  s_barrier
  s_cmp_eq_u32 s50, 3
  s_cbranch_scc1 l_last
  s_lshr_b32 s57, s42, 7
  s_add_u32 s57, s57, s52
  s_and_b32 s57, s57, 7
  s_cmp_eq_u32 s57, 3
  s_cbranch_scc0 l_nopf1
  s_bitcmp1_b32 s50, 0
  s_cselect_b32 s8, s42, s44
  s_cselect_b32 s9, s43, s45
  s_mov_b32 s57, 3145728
  buffer_load_dword v31, v35, s[8:11], s57 offen
l_nopf1:
  s_cmp_lg_u32 s50, 0
  s_cbranch_scc1 l_noalt
  v_lshrrev_b32 v1, 3, v247
  v_and_b32 v2, 7, v247
  v_mov_b32 v5, 1073741824
  v_lshrrev_b32 v7, 1, v1
  s_xor_b32 s51, s51, 8
  s_mul_i32 s65, s56, 36
  v_add_u32 v8, s65, v247
  s_lshl_b32 s64, s51, 7
  s_sub_u32 s64, s64, 16
  v_add_u32 v8, s64, v8
  v_lshlrev_b32 v59, 3, v8
  v_cmp_gt_i32 vcc, 0, v8
  s_nop 1
  v_cndmask_b32 v59, v59, v5, vcc
  v_cmp_le_u32 vcc, 36, v247
  s_nop 1
  v_cndmask_b32 v59, v59, v5, vcc
  s_lshl_b32 s64, s51, 7
  s_sub_u32 s64, s64, 16
  s_lshl_b32 s65, s56, 5
  s_add_u32 s65, s65, s64
  v_add_u32 v8, 0, v1
  v_add_u32 v8, s65, v8
  v_xor_b32 v9, 0, v7
  v_xor_b32 v9, v9, v2
  v_ashrrev_i32 v3, 7, v8
  v_lshlrev_b32 v54, 18, v3
  v_bfe_u32 v3, v8, 4, 3
  v_lshl_add_u32 v54, v3, 11, v54
  v_lshrrev_b32_e64 v3, 2, v9
  v_lshl_add_u32 v54, v3, 10, v54
  v_and_b32_e64 v3, 15, v8
  v_lshl_add_u32 v54, v3, 6, v54
  v_and_b32_e64 v3, 3, v9
  v_lshl_add_u32 v54, v3, 4, v54
  v_cmp_gt_i32 vcc, 0, v8
  s_nop 1
  v_cndmask_b32 v54, v54, v5, vcc
  v_add_u32 v8, 8, v1
  v_add_u32 v8, s65, v8
  v_xor_b32 v9, 4, v7
  v_xor_b32 v9, v9, v2
  v_ashrrev_i32 v3, 7, v8
  v_lshlrev_b32_e64 v55, 18, v3
  v_bfe_u32 v3, v8, 4, 3
  v_lshl_add_u32 v55, v3, 11, v55
  v_lshrrev_b32_e64 v3, 2, v9
  v_lshl_add_u32 v55, v3, 10, v55
  v_and_b32_e64 v3, 15, v8
  v_lshl_add_u32 v55, v3, 6, v55
  v_and_b32_e64 v3, 3, v9
  v_lshl_add_u32 v55, v3, 4, v55
  v_cmp_gt_i32 vcc, 0, v8
  s_nop 1
  v_cndmask_b32 v55, v55, v5, vcc
  v_add_u32 v8, 16, v1
  v_add_u32 v8, s65, v8
  v_xor_b32 v9, 0, v7
  v_xor_b32 v9, v9, v2
  v_ashrrev_i32 v3, 7, v8
  v_lshlrev_b32_e64 v56, 18, v3
  v_bfe_u32 v3, v8, 4, 3
  v_lshl_add_u32 v56, v3, 11, v56
  v_lshrrev_b32_e64 v3, 2, v9
  v_lshl_add_u32 v56, v3, 10, v56
  v_and_b32_e64 v3, 15, v8
  v_lshl_add_u32 v56, v3, 6, v56
  v_and_b32_e64 v3, 3, v9
  v_lshl_add_u32 v56, v3, 4, v56
  v_cmp_gt_i32 vcc, 0, v8
  s_nop 1
  v_cndmask_b32 v56, v56, v5, vcc
  v_add_u32 v8, 24, v1
  v_add_u32 v8, s65, v8
  v_xor_b32 v9, 4, v7
  v_xor_b32 v9, v9, v2
  v_ashrrev_i32 v3, 7, v8
  v_lshlrev_b32_e64 v57, 18, v3
  v_bfe_u32 v3, v8, 4, 3
  v_lshl_add_u32 v57, v3, 11, v57
  v_lshrrev_b32_e64 v3, 2, v9
  v_lshl_add_u32 v57, v3, 10, v57
  v_and_b32_e64 v3, 15, v8
  v_lshl_add_u32 v57, v3, 6, v57
  v_and_b32_e64 v3, 3, v9
  v_lshl_add_u32 v57, v3, 4, v57
  v_cmp_gt_i32 vcc, 0, v8
  s_nop 1
  v_cndmask_b32_e64 v57, v57, v5, vcc
  s_lshl_b32 s65, s56, 2
  s_add_u32 s65, s65, s64
  s_add_u32 s65, s65, 128
  v_add_u32 v8, s65, v1
  s_lshl_b32 s65, s56, 1
  v_add_u32 v9, s65, v7
  v_and_b32 v9, 7, v9
  v_xor_b32 v9, v9, v2
  v_ashrrev_i32 v3, 7, v8
  v_lshlrev_b32_e64 v58, 18, v3
  v_bfe_u32 v3, v8, 4, 3
  v_lshl_add_u32 v58, v3, 11, v58
  v_lshrrev_b32_e64 v3, 2, v9
  v_lshl_add_u32 v58, v3, 10, v58
  v_and_b32_e64 v3, 15, v8
  v_lshl_add_u32 v58, v3, 6, v58
  v_and_b32_e64 v3, 3, v9
  v_lshl_add_u32 v58, v3, 4, v58
  v_and_b32_e64 v8, 15, v247
  v_mul_u32_u24 v8, 1024, v8
  s_max_u32 s66, s51, 1
  s_sub_u32 s66, s66, 1
  s_mul_i32 s66, s66, 16384
  s_mul_i32 s65, s51, 16384
  v_add_u32 v61, s65, v8
  v_add_u32 v9, s66, v8
  v_cmp_le_u32 vcc, 16, v247
  s_nop 1
  v_cndmask_b32 v61, v61, v9, vcc
  s_xor_b32 s51, s51, 8
  v_and_b32_e64 v8, 15, v247
  v_mul_u32_u24 v8, 1024, v8
  s_xor_b32 s65, s53, 8
  s_mul_i32 s65, s65, 16384
  v_add_u32 v60, s65, v8
l_noalt:
  v_swap_b32 v40, v54
  v_swap_b32 v41, v55
  v_swap_b32 v42, v56
  v_swap_b32 v43, v57
  v_swap_b32 v44, v58
  v_swap_b32 v32, v59
  v_swap_b32 v28, v61
  v_swap_b32 v29, v60
  v_mov_b32 v10, v40
  v_mov_b32 v11, v41
  v_mov_b32 v12, v42
  v_mov_b32 v13, v43
  v_mov_b32_e64 v14, v44
  s_barrier
  s_add_u32 s50, s50, 1
  s_lshl_b32 s57, s50, 22
  s_add_u32 s58, s36, s57
  s_addc_u32 s59, s37, 0
  s_cmp_eq_u32 s50, 0
  s_cselect_b32 s4, s38, s58
  s_cselect_b32 s5, s39, s59
  s_mov_b32 s57, 262144
  s_cselect_b32 s18, 16384, s57
  s_add_u32 s12, s58, 16777216
  s_addc_u32 s13, s59, 0
  s_add_u32 s58, s58, 4194304
  s_addc_u32 s59, s59, 0
  s_cmp_eq_u32 s50, 3
  s_cselect_b32 s24, s40, s58
  s_cselect_b32 s25, s41, s59
  s_lshl_b32 s57, s50, 18
  s_add_u32 s57, s57, 33554432
  s_add_u32 s16, s36, s57
  s_addc_u32 s17, s37, 0
  s_add_u32 s28, s16, 262144
  s_addc_u32 s29, s17, 0
  s_bitcmp1_b32 s50, 0
  s_cselect_b32 s8, s44, s42
  s_cselect_b32 s9, s45, s43
  s_cselect_b32 s20, s48, s46
  s_cselect_b32 s21, s49, s47
  s_mov_b32 s85, 16384
  s_mov_b32 s74, s56
  s_add_u32 s88, s89, 0
  s_and_b32 s88, s88, 15
  s_mul_i32 s88, s88, 393216
  s_add_u32 m0, s72, 0
  s_nop 0
  buffer_load_dwordx4 v15, s[8:11], s88 offen lds
  s_add_u32 m0, s72, 1024
  s_nop 0
  buffer_load_dwordx4 v16, s[8:11], s88 offen lds
  s_add_u32 m0, s72, 2048
  s_nop 0
  buffer_load_dwordx4 v17, s[8:11], s88 offen lds
  s_add_u32 m0, s72, 3072
  s_nop 0
  buffer_load_dwordx4 v18, s[8:11], s88 offen lds
  s_add_u32 m0, s72, 4096
  s_nop 0
  buffer_load_dwordx4 v19, s[8:11], s88 offen lds
  s_add_u32 m0, s72, 5120
  s_nop 0
  buffer_load_dwordx4 v20, s[8:11], s88 offen lds
  s_add_u32 s88, s89, 1
  s_and_b32 s88, s88, 15
  s_mul_i32 s88, s88, 393216
  s_add_u32 m0, s72, 24576
  s_nop 0
  buffer_load_dwordx4 v15, s[8:11], s88 offen lds
  s_add_u32 m0, s72, 25600
  s_nop 0
  buffer_load_dwordx4 v16, s[8:11], s88 offen lds
  s_add_u32 m0, s72, 26624
  s_nop 0
  buffer_load_dwordx4 v17, s[8:11], s88 offen lds
  s_add_u32 m0, s72, 27648
  s_nop 0
  buffer_load_dwordx4 v18, s[8:11], s88 offen lds
  s_add_u32 m0, s72, 28672
  s_nop 0
  buffer_load_dwordx4 v19, s[8:11], s88 offen lds
  s_add_u32 m0, s72, 29696
  s_nop 0
  buffer_load_dwordx4 v20, s[8:11], s88 offen lds
  s_add_u32 s88, s89, 2
  s_and_b32 s88, s88, 15
  s_mul_i32 s88, s88, 393216
  s_add_u32 m0, s72, 49152
  s_nop 0
  buffer_load_dwordx4 v15, s[8:11], s88 offen lds
  s_add_u32 m0, s72, 50176
  s_nop 0
  buffer_load_dwordx4 v16, s[8:11], s88 offen lds
  s_add_u32 m0, s72, 51200
  s_nop 0
  buffer_load_dwordx4 v17, s[8:11], s88 offen lds
  s_add_u32 m0, s72, 52224
  s_nop 0
  buffer_load_dwordx4 v18, s[8:11], s88 offen lds
  s_add_u32 m0, s72, 53248
  s_nop 0
  buffer_load_dwordx4 v19, s[8:11], s88 offen lds
  s_add_u32 m0, s72, 54272
  s_nop 0
  buffer_load_dwordx4 v20, s[8:11], s88 offen lds
  s_branch l_layer
l_last:
  s_barrier
  s_endpgm
m_exit:
  s_endpgm
.section .rodata,"a"
.p2align 6
.amdhsa_kernel interleave_layers__sliding_local_dilated__sliding_local_dilated__prompt_kernel
  .amdhsa_next_free_vgpr 256
  .amdhsa_next_free_sgpr 102
  .amdhsa_accum_offset 256
  .amdhsa_group_segment_fixed_size 0
  .amdhsa_kernarg_size 72
  .amdhsa_user_sgpr_count 2
  .amdhsa_user_sgpr_kernarg_segment_ptr 1
  .amdhsa_system_sgpr_workgroup_id_x 1
.end_amdhsa_kernel
```
